```python
import torch

def _softmax(x, axis=-1):
    return torch.softmax(x, dim=axis)
def _gelu(x):
    return torch.nn.functional.gelu(x, approximate="tanh")
def _silu(x):
    return torch.nn.functional.silu(x)
def _sigmoid(x):
    return torch.sigmoid(x)
def _layernorm(x, axis=-1, eps=1e-5):
    m = x.mean(dim=axis, keepdim=True)
    v = x.var(dim=axis, keepdim=True, unbiased=False)
    return (x - m) / torch.sqrt(v + eps)
def _scatter_add(tgt, idx, src, axis=0):
    return tgt.clone().index_add_(axis, idx, src)
def _segment_sum(src, seg, n):
    out = torch.zeros((n,) + src.shape[1:], dtype=src.dtype)
    return out.index_add_(0, seg, src)
def _pad(x, pw):
    flat = tuple(v for pair in reversed(pw) for v in pair)
    return torch.nn.functional.pad(x, flat)

kernel_name = 'recurrent_scan__gqa_block_cached__mixer_token_mlp__decode'

def setup_inputs():

    _w = (lambda a: (lambda t: t.to(torch.bfloat16) if t.is_floating_point() else t)(torch.as_tensor(a)))
    def _A_setup():
        B, Sq, D = 2, 1, 576
        Hq, Hkv, Sk, Dh = 32, 16, 8192, 128
        assert Hq % Hkv == 0, (Hq, Hkv)
        return {
            "x": _w((lambda *s: torch.randn(*s, dtype=torch.bfloat16) * 0.1)(B, Sq, D)),
            "k_cache": _w((lambda *s: torch.randn(*s, dtype=torch.bfloat16) * 0.8)(B, Hkv, Sk, Dh)),
            "v_cache": _w((lambda *s: torch.randn(*s, dtype=torch.bfloat16) * 3.2)(B, Hkv, Sk, Dh)),
            "wq": _w((lambda *s: torch.randn(*s, dtype=torch.bfloat16) * 0.8)(D, Hq * Dh) * (D ** -0.5)),
            "wo": _w((lambda *s: torch.randn(*s, dtype=torch.bfloat16) * 3.2)(Hq * Dh, D) * ((Hq * Dh) ** -0.5)),
        }
    _A_in = _A_setup()

    def _B_setup():
        B, S, D, F = 2, 1, 576, 4608
        return {
            "x": _w((lambda *s: torch.randn(*s, dtype=torch.bfloat16) * 0.1)(B, S, D)),
            "w1": _w((lambda *s: torch.randn(*s, dtype=torch.bfloat16) * 3.2)(S, F) * (S ** -0.5)),
            "b1": _w((lambda *s: torch.randn(*s, dtype=torch.bfloat16) * 3.2)(F) * 0.02),
            "w2": _w((lambda *s: torch.randn(*s, dtype=torch.bfloat16) * 3.2)(F, S) * (F ** -0.5)),
            "b2": _w((lambda *s: torch.randn(*s, dtype=torch.bfloat16) * 3.2)(S) * 0.02),
        }
    _B_in = _B_setup()

    return {
        "A_x": _A_in["x"],
        "A_k_cache": _A_in["k_cache"],
        "A_v_cache": _A_in["v_cache"],
        "A_wq": _A_in["wq"],
        "A_wo": _A_in["wo"],
        "B_x": _B_in["x"],
        "B_w1": _B_in["w1"],
        "B_b1": _B_in["b1"],
        "B_w2": _B_in["w2"],
        "B_b2": _B_in["b2"],
    }

def reference(A_x, A_k_cache, A_v_cache, A_wq, A_wo, B_x, B_w1, B_b1, B_w2, B_b2):
    def _A_ref(x, k_cache, v_cache, wq, wo):
        B, Sq, D = x.shape
        Hq, Dh = 32, 128
        Hkv = k_cache.shape[1]
        rep = Hq // Hkv
        q = (lambda x, *d: x.permute(*d))((x @ wq).reshape(B, Sq, Hq, Dh), 0, 2, 1, 3)
        k = (lambda x, n, axis: torch.repeat_interleave(x, n, dim=axis))(k_cache, rep, axis=1)
        v = (lambda x, n, axis: torch.repeat_interleave(x, n, dim=axis))(v_cache, rep, axis=1)
        scores = torch.einsum("bhqd,bhkd->bhqk", q, k) * (Dh ** -0.5)
        p = _softmax(scores, axis=-1)
        o = torch.einsum("bhqk,bhkd->bhqd", p, v)
        return (lambda x, *d: x.permute(*d))(o, 0, 2, 1, 3).reshape(B, Sq, Hq * Dh) @ wo

    def _B_ref(x, w1, b1, w2, b2):
        B, S, D = x.shape
        h = _layernorm(x, axis=-1)
        u = torch.einsum("bsd,sf->bdf", h, w1) + b1
        u = _gelu(u)
        y = torch.einsum("bdf,fs->bds", u, w2) + b2
        return (lambda x, *d: x.permute(*d))(y, 0, 2, 1)

    x = A_x
    xn = _layernorm(x, axis=-1)
    s = _A_ref(xn, A_k_cache, A_v_cache, A_wq, A_wo)
    g = _silu(_B_ref(xn, B_w1, B_b1, B_w2, B_b2))
    return x + s * g
```

```asm
; @launch grid=(256,1,1) block=(512,1,1) lds=96256
.amdgcn_target "amdgcn-amd-amdhsa--gfx950"
.text
.globl recurrent_scan__gqa_block_cached__mixer_token_mlp__decode_kernel
.p2align 8
.type recurrent_scan__gqa_block_cached__mixer_token_mlp__decode_kernel,@function
recurrent_scan__gqa_block_cached__mixer_token_mlp__decode_kernel:
    s_cmp_ge_u32 s2, 256
    s_cbranch_scc1 L_end
    s_load_dwordx16 s[4:19], s[0:1], 0
    s_load_dwordx8 s[20:27], s[0:1], 64
    s_load_dwordx2 s[28:29], s[0:1], 96
    v_cmp_gt_u32 vcc, 448, v0
    v_lshrrev_b32 v1, 6, v0
    v_and_b32 v0, 63, v0
    s_cbranch_vccnz L_noinit
    v_lshlrev_b32 v21, 2, v0
    v_mov_b32 v22, -1
    ds_write_b32 v21, v22 offset:768
    v_and_b32 v2, 15, v0
    v_cmp_lt_u32 vcc, 8, v2
    v_cmp_lt_u32 s[40:41], 15, v0
    s_and_b64 vcc, vcc, s[40:41]
    v_cndmask_b32 v22, v22, 0, vcc
    ds_write_b32 v21, v22 offset:512
L_noinit:
    v_mov_b32 v23, 0
    s_and_b32 s31, s2, 7
    v_readfirstlane_b32 s30, v1
    s_lshr_b32 s3, s2, 3
    s_lshl_b32 s31, s31, 1
    s_lshr_b32 s32, s3, 4
    s_add_u32 s31, s31, s32
    s_bfe_u32 s32, s3, 0x10003
    s_and_b32 s33, s3, 7
    s_lshl_b32 s34, s32, 4
    s_add_u32 s34, s34, s31
    s_mov_b32 s43, 0x20000
    s_cmp_ge_u32 s30, 4
    s_cbranch_scc1 L_service
    v_and_b32 v3, 3, v0
    v_lshlrev_b32 v1, 4, v3
    v_bfe_u32 v3, v0, 2, 2
    v_lshl_add_u32 v1, v3, 8, v1
    v_lshrrev_b32 v3, 4, v0
    v_lshl_add_u32 v1, v3, 6, v1
    s_lshl_b32 s48, s34, 21
    s_lshl_b32 s3, s33, 18
    s_add_u32 s48, s48, s3
    s_mov_b32 s42, 0x4000000
    s_mul_i32 s54, s32, 32
    s_mul_i32 s3, s33, 4
    s_add_u32 s54, s54, s3
    s_add_u32 s54, s54, s30
    s_and_b32 s54, s54, 63
    s_lshl_b32 s54, s54, 12
    s_add_u32 s49, s48, s54
    s_mul_i32 s53, s30, 20480
    s_add_u32 s53, s53, 14336
    s_mov_b32 m0, s53
    s_setprio 2
    s_waitcnt lgkmcnt(0)
    s_mov_b32 s40, s6
    s_mov_b32 s41, s7
    buffer_load_dwordx4 v1, s[40:43], s49 offen offset:0 nt lds
    buffer_load_dwordx4 v1, s[40:43], s49 offen offset:1024 nt lds
    buffer_load_dwordx4 v1, s[40:43], s49 offen offset:2048 nt lds
    buffer_load_dwordx4 v1, s[40:43], s49 offen offset:3072 nt lds
    s_add_u32 m0, m0, 0x1000
    s_add_u32 s54, s54, 0x4000
    s_and_b32 s54, s54, 0x3ffff
    s_add_u32 s49, s48, s54
    buffer_load_dwordx4 v1, s[40:43], s49 offen offset:0 nt lds
    buffer_load_dwordx4 v1, s[40:43], s49 offen offset:1024 nt lds
    buffer_load_dwordx4 v1, s[40:43], s49 offen offset:2048 nt lds
    buffer_load_dwordx4 v1, s[40:43], s49 offen offset:3072 nt lds
    s_barrier
    s_branch L_stream
L_service:
    s_setprio 3
    v_and_b32 v3, 31, v0
    v_lshrrev_b32 v13, 5, v0
    v_mul_u32_u24 v14, 1152, v13
    v_lshl_add_u32 v1, v3, 4, v14
    v_lshl_add_u32 v2, v3, 2, v14
    s_sub_u32 s37, s30, 4
    v_and_b32 v14, 15, v0
    v_lshrrev_b32 v15, 4, v0
    s_mul_i32 s48, s33, 589824
    s_lshl_b32 s3, s31, 9
    s_add_u32 s48, s48, s3
    s_lshl_b32 s3, s32, 8
    s_add_u32 s48, s48, s3
    s_mov_b32 s3, 147456
    v_mul_lo_u32 v16, v15, s3
    v_lshl_add_u32 v16, v14, 4, v16
    s_mov_b32 s42, 4718592
    s_lshl_b32 s35, s31, 3
    s_add_u32 s35, s35, s33
    s_cmp_lg_u32 s37, 0
    s_waitcnt lgkmcnt(0)
    global_load_dwordx4 v[4:7], v1, s[4:5]
    global_load_dwordx4 v[8:11], v1, s[4:5] offset:512
    global_load_dword v12, v2, s[4:5] offset:1024
    s_cbranch_scc1 L_s123a
    s_mov_b32 s40, s10
    s_mov_b32 s41, s11
    buffer_load_dwordx4 v[64:67], v16, s[40:43], s48 offen nt
    s_add_u32 s48, s48, 8192
    buffer_load_dwordx4 v[68:71], v16, s[40:43], s48 offen nt
    s_add_u32 s48, s48, 8192
    buffer_load_dwordx4 v[72:75], v16, s[40:43], s48 offen nt
    s_add_u32 s48, s48, 8192
    buffer_load_dwordx4 v[76:79], v16, s[40:43], s48 offen nt
    s_add_u32 s48, s48, 8192
    buffer_load_dwordx4 v[80:83], v16, s[40:43], s48 offen nt
    s_add_u32 s48, s48, 8192
    buffer_load_dwordx4 v[84:87], v16, s[40:43], s48 offen nt
    s_add_u32 s48, s48, 8192
    buffer_load_dwordx4 v[88:91], v16, s[40:43], s48 offen nt
    s_add_u32 s48, s48, 8192
    buffer_load_dwordx4 v[92:95], v16, s[40:43], s48 offen nt
    s_add_u32 s48, s48, 8192
    buffer_load_dwordx4 v[96:99], v16, s[40:43], s48 offen nt
    s_add_u32 s48, s48, 8192
    buffer_load_dwordx4 v[100:103], v16, s[40:43], s48 offen nt
    s_add_u32 s48, s48, 8192
    buffer_load_dwordx4 v[104:107], v16, s[40:43], s48 offen nt
    s_add_u32 s48, s48, 8192
    buffer_load_dwordx4 v[108:111], v16, s[40:43], s48 offen nt
    s_add_u32 s48, s48, 8192
    buffer_load_dwordx4 v[112:115], v16, s[40:43], s48 offen nt
    s_add_u32 s48, s48, 8192
    buffer_load_dwordx4 v[116:119], v16, s[40:43], s48 offen nt
    s_add_u32 s48, s48, 8192
    buffer_load_dwordx4 v[120:123], v16, s[40:43], s48 offen nt
    s_add_u32 s48, s48, 8192
    buffer_load_dwordx4 v[124:127], v16, s[40:43], s48 offen nt
    s_add_u32 s48, s48, 8192
    buffer_load_dwordx4 v[128:131], v16, s[40:43], s48 offen nt
    s_add_u32 s48, s48, 8192
    buffer_load_dwordx4 v[132:135], v16, s[40:43], s48 offen nt
    s_barrier
    s_mov_b32 s38, 1
    s_waitcnt vmcnt(18)
    s_branch L_ln0
L_s123a:
    s_and_b32 s3, s33, 1
    s_mul_i32 s3, s3, 4608
    s_mul_i32 s36, s37, 1536
    s_add_u32 s3, s3, s36
    s_sub_u32 s3, s3, 1536
    v_lshl_add_u32 v16, v0, 4, s3
    v_lshl_add_u32 v17, v0, 3, s3
    s_lshl_b32 s3, s2, 2
    s_add_u32 s3, s3, s37
    s_cmp_lg_u32 s3, 3
    s_cbranch_scc1 L_s12a
    s_memrealtime s[60:61]
    s_waitcnt lgkmcnt(0)
    s_mul_i32 s60, s60, 0x01010101
    s_max_u32 s60, s60, 1
    v_mov_b32 v22, s60
    s_mov_b64 exec, 1
    global_store_dword v23, v22, s[26:27] sc1
    s_mov_b64 exec, -1
L_s12a:
    global_load_dwordx4 v[64:67], v16, s[16:17]
    global_load_dwordx2 v[68:69], v17, s[16:17] offset:1024
    global_load_dwordx4 v[70:73], v16, s[18:19]
    global_load_dwordx2 v[74:75], v17, s[18:19] offset:1024
    global_load_dwordx4 v[76:79], v16, s[20:21]
    global_load_dwordx2 v[80:81], v17, s[20:21] offset:1024
    s_barrier
    s_setprio 0
    s_mov_b32 s38, 2
    s_waitcnt vmcnt(6)
L_ln0:
    s_mov_b32 s39, 0xffff0000
    s_mov_b32 s52, 3000000
    s_mov_b32 s51, 1069066811
L_ln:
    v_lshlrev_b32 v24, 16, v4
    v_and_b32 v25, s39, v4
    v_lshlrev_b32 v26, 16, v5
    v_and_b32 v27, s39, v5
    v_lshlrev_b32 v28, 16, v6
    v_and_b32 v29, s39, v6
    v_lshlrev_b32 v30, 16, v7
    v_and_b32 v31, s39, v7
    v_lshlrev_b32 v32, 16, v8
    v_and_b32 v33, s39, v8
    v_lshlrev_b32 v34, 16, v9
    v_and_b32 v35, s39, v9
    v_lshlrev_b32 v36, 16, v10
    v_and_b32 v37, s39, v10
    v_lshlrev_b32 v38, 16, v11
    v_and_b32 v39, s39, v11
    v_lshlrev_b32 v40, 16, v12
    v_and_b32 v41, s39, v12
    v_pk_add_f32 v[42:43], v[24:25], v[26:27]
    v_pk_add_f32 v[42:43], v[42:43], v[28:29]
    v_pk_add_f32 v[42:43], v[42:43], v[30:31]
    v_pk_add_f32 v[42:43], v[42:43], v[32:33]
    v_pk_add_f32 v[42:43], v[42:43], v[34:35]
    v_pk_add_f32 v[42:43], v[42:43], v[36:37]
    v_pk_add_f32 v[42:43], v[42:43], v[38:39]
    v_pk_add_f32 v[42:43], v[42:43], v[40:41]
    v_add_f32 v42, v42, v43
    s_nop 1
    v_add_f32_dpp v42, v42, v42 quad_perm:[1,0,3,2] row_mask:0xf bank_mask:0xf
    s_nop 1
    v_add_f32_dpp v42, v42, v42 quad_perm:[2,3,0,1] row_mask:0xf bank_mask:0xf
    s_nop 1
    v_add_f32_dpp v42, v42, v42 row_half_mirror row_mask:0xf bank_mask:0xf
    s_nop 1
    v_add_f32_dpp v42, v42, v42 row_mirror row_mask:0xf bank_mask:0xf
    v_mov_b32 v43, v42
    s_nop 1
    v_permlane16_swap_b32 v42, v43
    v_add_f32 v42, v42, v43
    v_mul_f32 v42, 0x3ae38e39, v42
    v_pk_add_f32 v[44:45], v[24:25], v[42:43] op_sel_hi:[1,0] neg_lo:[0,1] neg_hi:[0,1]
    v_pk_add_f32 v[46:47], v[26:27], v[42:43] op_sel_hi:[1,0] neg_lo:[0,1] neg_hi:[0,1]
    v_pk_add_f32 v[48:49], v[28:29], v[42:43] op_sel_hi:[1,0] neg_lo:[0,1] neg_hi:[0,1]
    v_pk_add_f32 v[50:51], v[30:31], v[42:43] op_sel_hi:[1,0] neg_lo:[0,1] neg_hi:[0,1]
    v_pk_add_f32 v[52:53], v[32:33], v[42:43] op_sel_hi:[1,0] neg_lo:[0,1] neg_hi:[0,1]
    v_pk_add_f32 v[54:55], v[34:35], v[42:43] op_sel_hi:[1,0] neg_lo:[0,1] neg_hi:[0,1]
    v_pk_add_f32 v[56:57], v[36:37], v[42:43] op_sel_hi:[1,0] neg_lo:[0,1] neg_hi:[0,1]
    v_pk_add_f32 v[58:59], v[38:39], v[42:43] op_sel_hi:[1,0] neg_lo:[0,1] neg_hi:[0,1]
    v_pk_add_f32 v[60:61], v[40:41], v[42:43] op_sel_hi:[1,0] neg_lo:[0,1] neg_hi:[0,1]
    v_cvt_pk_bf16_f32 v42, v42, v42
    v_lshlrev_b32 v42, 16, v42
    v_pk_mul_f32 v[62:63], v[44:45], v[44:45]
    v_pk_fma_f32 v[62:63], v[46:47], v[46:47], v[62:63]
    v_pk_fma_f32 v[62:63], v[48:49], v[48:49], v[62:63]
    v_pk_fma_f32 v[62:63], v[50:51], v[50:51], v[62:63]
    v_pk_fma_f32 v[62:63], v[52:53], v[52:53], v[62:63]
    v_pk_fma_f32 v[62:63], v[54:55], v[54:55], v[62:63]
    v_pk_fma_f32 v[62:63], v[56:57], v[56:57], v[62:63]
    v_pk_fma_f32 v[62:63], v[58:59], v[58:59], v[62:63]
    v_pk_fma_f32 v[62:63], v[60:61], v[60:61], v[62:63]
    v_add_f32 v62, v62, v63
    v_pk_add_f32 v[24:25], v[24:25], v[42:43] op_sel_hi:[1,0] neg_lo:[0,1] neg_hi:[0,1]
    v_pk_add_f32 v[26:27], v[26:27], v[42:43] op_sel_hi:[1,0] neg_lo:[0,1] neg_hi:[0,1]
    v_add_f32_dpp v62, v62, v62 quad_perm:[1,0,3,2] row_mask:0xf bank_mask:0xf
    v_pk_add_f32 v[28:29], v[28:29], v[42:43] op_sel_hi:[1,0] neg_lo:[0,1] neg_hi:[0,1]
    v_pk_add_f32 v[30:31], v[30:31], v[42:43] op_sel_hi:[1,0] neg_lo:[0,1] neg_hi:[0,1]
    v_add_f32_dpp v62, v62, v62 quad_perm:[2,3,0,1] row_mask:0xf bank_mask:0xf
    v_pk_add_f32 v[32:33], v[32:33], v[42:43] op_sel_hi:[1,0] neg_lo:[0,1] neg_hi:[0,1]
    v_pk_add_f32 v[34:35], v[34:35], v[42:43] op_sel_hi:[1,0] neg_lo:[0,1] neg_hi:[0,1]
    v_add_f32_dpp v62, v62, v62 row_half_mirror row_mask:0xf bank_mask:0xf
    v_pk_add_f32 v[36:37], v[36:37], v[42:43] op_sel_hi:[1,0] neg_lo:[0,1] neg_hi:[0,1]
    v_pk_add_f32 v[38:39], v[38:39], v[42:43] op_sel_hi:[1,0] neg_lo:[0,1] neg_hi:[0,1]
    v_add_f32_dpp v62, v62, v62 row_mirror row_mask:0xf bank_mask:0xf
    v_pk_add_f32 v[40:41], v[40:41], v[42:43] op_sel_hi:[1,0] neg_lo:[0,1] neg_hi:[0,1]
    v_cvt_pk_bf16_f32 v4, v24, v25
    v_mov_b32 v63, v62
    v_cvt_pk_bf16_f32 v5, v26, v27
    v_cvt_pk_bf16_f32 v6, v28, v29
    v_permlane16_swap_b32 v62, v63
    v_cvt_pk_bf16_f32 v7, v30, v31
    v_cvt_pk_bf16_f32 v8, v32, v33
    v_add_f32 v62, v62, v63
    v_cvt_pk_bf16_f32 v9, v34, v35
    v_cvt_pk_bf16_f32 v10, v36, v37
    v_mul_f32 v62, 0x3ae38e39, v62
    v_cvt_pk_bf16_f32 v11, v38, v39
    v_cvt_pk_bf16_f32 v12, v40, v41
    v_cvt_pk_bf16_f32 v62, v62, v62
    v_lshlrev_b32 v62, 16, v62
    v_lshlrev_b32 v24, 16, v4
    v_and_b32 v25, s39, v4
    v_add_f32 v62, 0x3727c5ac, v62
    v_lshlrev_b32 v26, 16, v5
    v_and_b32 v27, s39, v5
    v_cvt_pk_bf16_f32 v62, v62, v62
    v_lshlrev_b32 v62, 16, v62
    v_lshlrev_b32 v28, 16, v6
    v_and_b32 v29, s39, v6
    v_sqrt_f32 v62, v62
    v_lshlrev_b32 v30, 16, v7
    v_and_b32 v31, s39, v7
    v_cvt_pk_bf16_f32 v62, v62, v62
    v_lshlrev_b32 v62, 16, v62
    v_lshlrev_b32 v32, 16, v8
    v_and_b32 v33, s39, v8
    v_rcp_f32 v62, v62
    v_lshlrev_b32 v34, 16, v9
    v_and_b32 v35, s39, v9
    v_lshlrev_b32 v36, 16, v10
    v_and_b32 v37, s39, v10
    v_lshlrev_b32 v38, 16, v11
    v_and_b32 v39, s39, v11
    v_lshlrev_b32 v40, 16, v12
    v_and_b32 v41, s39, v12
    v_pk_mul_f32 v[24:25], v[24:25], v[62:63] op_sel_hi:[1,0]
    v_pk_mul_f32 v[26:27], v[26:27], v[62:63] op_sel_hi:[1,0]
    v_pk_mul_f32 v[28:29], v[28:29], v[62:63] op_sel_hi:[1,0]
    v_pk_mul_f32 v[30:31], v[30:31], v[62:63] op_sel_hi:[1,0]
    v_pk_mul_f32 v[32:33], v[32:33], v[62:63] op_sel_hi:[1,0]
    v_pk_mul_f32 v[34:35], v[34:35], v[62:63] op_sel_hi:[1,0]
    v_pk_mul_f32 v[36:37], v[36:37], v[62:63] op_sel_hi:[1,0]
    v_pk_mul_f32 v[38:39], v[38:39], v[62:63] op_sel_hi:[1,0]
    v_pk_mul_f32 v[40:41], v[40:41], v[62:63] op_sel_hi:[1,0]
    v_cvt_pk_bf16_f32 v4, v24, v25
    v_cvt_pk_bf16_f32 v5, v26, v27
    v_cvt_pk_bf16_f32 v6, v28, v29
    v_cvt_pk_bf16_f32 v7, v30, v31
    v_cvt_pk_bf16_f32 v8, v32, v33
    v_cvt_pk_bf16_f32 v9, v34, v35
    v_cvt_pk_bf16_f32 v10, v36, v37
    v_cvt_pk_bf16_f32 v11, v38, v39
    v_cvt_pk_bf16_f32 v12, v40, v41
    s_sub_u32 s38, s38, 1
    s_cmp_lg_u32 s38, 0
    s_cbranch_scc1 L_ln
    s_mul_i32 s54, s37, 2304
    s_add_u32 s54, s54, 5120
    v_add_u32 v1, s54, v1
    v_add_u32 v2, s54, v2
    ds_write_b128 v1, v[4:7]
    ds_write_b128 v1, v[8:11] offset:512
    ds_write_b32 v2, v12 offset:1024
    v_mov_b32 v3, 0xff
    s_cmp_lg_u32 s37, 0
    s_cbranch_scc1 L_s123b
    s_load_dword s60, s[26:27], 0
    v_bfe_u32 v21, v0, 3, 1
    v_mul_u32_u24 v21, 1152, v21
    v_mul_u32_u24 v22, 36, v15
    s_mul_i32 s3, s33, 144
    s_add_u32 s3, s3, s54
    v_add3_u32 v21, v21, v22, s3
    ds_read2_b32 v[24:25], v21 offset0:0 offset1:1
    ds_read2_b32 v[26:27], v21 offset0:2 offset1:3
    ds_read2_b32 v[28:29], v21 offset0:4 offset1:5
    ds_read2_b32 v[30:31], v21 offset0:6 offset1:7
    ds_read_b32 v32, v21 offset:32
    v_and_b32 v21, 1, v0
    v_cmp_eq_u32 vcc, 1, v21
    v_mov_b32 v21, 0x0c0c0100
    v_mov_b32 v22, 0x01000c0c
    v_cndmask_b32 v139, v21, v22, vcc
    v_mov_b32 v21, 0x0c0c0302
    v_mov_b32 v22, 0x03020c0c
    v_cndmask_b32 v143, v21, v22, vcc
    v_bfe_u32 v21, v0, 1, 2
    v_mov_b32 v22, 0x0c0c0c0c
    v_cmp_eq_u32 vcc, 0, v21
    s_nop 1
    v_cndmask_b32 v136, v22, v139, vcc
    v_cndmask_b32 v140, v22, v143, vcc
    v_cmp_eq_u32 vcc, 1, v21
    s_nop 1
    v_cndmask_b32 v137, v22, v139, vcc
    v_cndmask_b32 v141, v22, v143, vcc
    v_cmp_eq_u32 vcc, 2, v21
    s_nop 1
    v_cndmask_b32 v138, v22, v139, vcc
    v_cndmask_b32 v142, v22, v143, vcc
    v_cmp_eq_u32 vcc, 3, v21
    s_nop 1
    v_cndmask_b32 v139, v22, v139, vcc
    v_cndmask_b32 v143, v22, v143, vcc
    v_lshrrev_b32 v22, 1, v15
    v_lshlrev_b32 v22, 13, v22
    v_and_b32 v21, 1, v15
    v_lshl_add_u32 v22, v21, 4, v22
    v_lshl_add_u32 v22, v14, 5, v22
    s_lshl_b32 s3, s31, 14
    s_lshl_b32 s36, s33, 10
    s_add_u32 s3, s3, s36
    s_lshl_b32 s36, s32, 9
    s_add_u32 s3, s3, s36
    v_add_u32 v22, s3, v22
    s_waitcnt vmcnt(0) lgkmcnt(0)
    v_perm_b32 v36, v24, v24, v136
    v_perm_b32 v37, v24, v24, v137
    v_perm_b32 v38, v24, v24, v138
    v_perm_b32 v39, v24, v24, v139
    s_nop 1
    v_mfma_f32_16x16x32_bf16 v[44:47], v[36:39], v[64:67], 0
    v_perm_b32 v40, v24, v24, v140
    v_perm_b32 v41, v24, v24, v141
    v_perm_b32 v42, v24, v24, v142
    v_perm_b32 v43, v24, v24, v143
    s_nop 1
    v_mfma_f32_16x16x32_bf16 v[44:47], v[40:43], v[68:71], v[44:47]
    v_perm_b32 v36, v25, v25, v136
    v_perm_b32 v37, v25, v25, v137
    v_perm_b32 v38, v25, v25, v138
    v_perm_b32 v39, v25, v25, v139
    s_nop 1
    v_mfma_f32_16x16x32_bf16 v[44:47], v[36:39], v[72:75], v[44:47]
    v_perm_b32 v40, v25, v25, v140
    v_perm_b32 v41, v25, v25, v141
    v_perm_b32 v42, v25, v25, v142
    v_perm_b32 v43, v25, v25, v143
    s_nop 1
    v_mfma_f32_16x16x32_bf16 v[44:47], v[40:43], v[76:79], v[44:47]
    v_perm_b32 v36, v26, v26, v136
    v_perm_b32 v37, v26, v26, v137
    v_perm_b32 v38, v26, v26, v138
    v_perm_b32 v39, v26, v26, v139
    s_nop 1
    v_mfma_f32_16x16x32_bf16 v[44:47], v[36:39], v[80:83], v[44:47]
    v_perm_b32 v40, v26, v26, v140
    v_perm_b32 v41, v26, v26, v141
    v_perm_b32 v42, v26, v26, v142
    v_perm_b32 v43, v26, v26, v143
    s_nop 1
    v_mfma_f32_16x16x32_bf16 v[44:47], v[40:43], v[84:87], v[44:47]
    v_perm_b32 v36, v27, v27, v136
    v_perm_b32 v37, v27, v27, v137
    v_perm_b32 v38, v27, v27, v138
    v_perm_b32 v39, v27, v27, v139
    s_nop 1
    v_mfma_f32_16x16x32_bf16 v[44:47], v[36:39], v[88:91], v[44:47]
    v_perm_b32 v40, v27, v27, v140
    v_perm_b32 v41, v27, v27, v141
    v_perm_b32 v42, v27, v27, v142
    v_perm_b32 v43, v27, v27, v143
    s_nop 1
    v_mfma_f32_16x16x32_bf16 v[44:47], v[40:43], v[92:95], v[44:47]
    v_perm_b32 v36, v28, v28, v136
    v_perm_b32 v37, v28, v28, v137
    v_perm_b32 v38, v28, v28, v138
    v_perm_b32 v39, v28, v28, v139
    s_nop 1
    v_mfma_f32_16x16x32_bf16 v[44:47], v[36:39], v[96:99], v[44:47]
    v_perm_b32 v40, v28, v28, v140
    v_perm_b32 v41, v28, v28, v141
    v_perm_b32 v42, v28, v28, v142
    v_perm_b32 v43, v28, v28, v143
    s_nop 1
    v_mfma_f32_16x16x32_bf16 v[44:47], v[40:43], v[100:103], v[44:47]
    v_perm_b32 v36, v29, v29, v136
    v_perm_b32 v37, v29, v29, v137
    v_perm_b32 v38, v29, v29, v138
    v_perm_b32 v39, v29, v29, v139
    s_nop 1
    v_mfma_f32_16x16x32_bf16 v[44:47], v[36:39], v[104:107], v[44:47]
    v_perm_b32 v40, v29, v29, v140
    v_perm_b32 v41, v29, v29, v141
    v_perm_b32 v42, v29, v29, v142
    v_perm_b32 v43, v29, v29, v143
    s_nop 1
    v_mfma_f32_16x16x32_bf16 v[44:47], v[40:43], v[108:111], v[44:47]
    v_perm_b32 v36, v30, v30, v136
    v_perm_b32 v37, v30, v30, v137
    v_perm_b32 v38, v30, v30, v138
    v_perm_b32 v39, v30, v30, v139
    s_nop 1
    v_mfma_f32_16x16x32_bf16 v[44:47], v[36:39], v[112:115], v[44:47]
    v_perm_b32 v40, v30, v30, v140
    v_perm_b32 v41, v30, v30, v141
    v_perm_b32 v42, v30, v30, v142
    v_perm_b32 v43, v30, v30, v143
    s_nop 1
    v_mfma_f32_16x16x32_bf16 v[44:47], v[40:43], v[116:119], v[44:47]
    v_perm_b32 v36, v31, v31, v136
    v_perm_b32 v37, v31, v31, v137
    v_perm_b32 v38, v31, v31, v138
    v_perm_b32 v39, v31, v31, v139
    s_nop 1
    v_mfma_f32_16x16x32_bf16 v[44:47], v[36:39], v[120:123], v[44:47]
    v_perm_b32 v40, v31, v31, v140
    v_perm_b32 v41, v31, v31, v141
    v_perm_b32 v42, v31, v31, v142
    v_perm_b32 v43, v31, v31, v143
    s_nop 1
    v_mfma_f32_16x16x32_bf16 v[44:47], v[40:43], v[124:127], v[44:47]
    v_perm_b32 v36, v32, v32, v136
    v_perm_b32 v37, v32, v32, v137
    v_perm_b32 v38, v32, v32, v138
    v_perm_b32 v39, v32, v32, v139
    s_nop 1
    v_mfma_f32_16x16x32_bf16 v[44:47], v[36:39], v[128:131], v[44:47]
    v_perm_b32 v40, v32, v32, v140
    v_perm_b32 v41, v32, v32, v141
    v_perm_b32 v42, v32, v32, v142
    v_perm_b32 v43, v32, v32, v143
    s_nop 1
    v_mfma_f32_16x16x32_bf16 v[44:47], v[40:43], v[132:135], v[44:47]
    s_cmp_lg_u32 s60, 0
    s_cbranch_scc1 L_gna
L_pna:
    global_load_dword v21, v23, s[26:27] sc1
    s_sub_u32 s52, s52, 1
    s_cbranch_scc1 L_gna
    s_waitcnt vmcnt(0)
    v_readfirstlane_b32 s60, v21
    s_sleep 8
    s_cmp_eq_u32 s60, 0
    s_cbranch_scc1 L_pna
L_gna:
    s_max_i32 s52, s52, 0
    s_and_b32 s64, s60, 0xff
    s_bfe_u32 s65, s60, 0x80008
    s_bfe_u32 s66, s60, 0x80010
    s_lshr_b32 s67, s60, 24
    s_getreg_b32 s87, hwreg(HW_REG_XCC_ID, 0, 4)
    s_xor_b32 s87, s87, s67
    s_add_u32 s62, s28, 2097152
    s_addc_u32 s63, s29, 0
    s_nop 4
    v_add_u32 v44, 0x80, v44
    v_add_u32 v45, 0x80, v45
    v_add_u32 v46, 0x80, v46
    v_add_u32 v47, 0x80, v47
    v_mov_b32 v48, v44
    v_mov_b32 v49, v45
    v_mov_b32 v50, v46
    v_mov_b32 v51, v47
    v_bfi_b32 v44, v3, s64, v44
    v_bfi_b32 v45, v3, s65, v45
    v_bfi_b32 v46, v3, s66, v46
    v_bfi_b32 v47, v3, s87, v47
    global_store_dwordx4 v22, v[44:47], s[62:63]
    s_lshl_b32 s3, s31, 14
    s_lshl_b32 s36, s32, 13
    s_add_u32 s3, s3, s36
    s_add_u32 s3, s3, 4096
    v_lshl_add_u32 v33, v0, 4, s3
    v_lshlrev_b32 v21, 3, v0
    s_mov_b32 s58, 24
    s_mov_b32 s59, 1
L_wmq:
    ds_read_b32 v24, v23 offset:772
    s_sub_u32 s52, s52, 1
    s_cbranch_scc1 L_gmq
    s_waitcnt lgkmcnt(0)
    v_cmp_gt_i32 vcc, 1, v24
    s_sleep 4
    s_cbranch_vccnz L_wmq
L_gmq:
    s_max_i32 s52, s52, 0
    s_waitcnt lgkmcnt(0)
L_pollq:
    s_mov_b32 s59, 1
    global_load_dwordx4 v[64:67], v33, s[62:63] offset:-4096 nt
    global_load_dwordx4 v[68:71], v33, s[62:63] offset:-3072 nt
    global_load_dwordx4 v[72:75], v33, s[62:63] offset:-2048 nt
    global_load_dwordx4 v[76:79], v33, s[62:63] offset:-1024 nt
    global_load_dwordx4 v[80:83], v33, s[62:63] offset:0 nt
    global_load_dwordx4 v[84:87], v33, s[62:63] offset:1024 nt
    global_load_dwordx4 v[88:91], v33, s[62:63] offset:2048 nt
    global_load_dwordx4 v[92:95], v33, s[62:63] offset:3072 nt
    s_sub_u32 s52, s52, 1
    s_cbranch_scc1 L_gotq
    s_waitcnt vmcnt(7)
    v_xor_b32 v64, s64, v64
    v_xor_b32 v65, s65, v65
    v_xor_b32 v66, s66, v66
    v_xor_b32 v67, s87, v67
    v_or3_b32 v24, v64, v65, v66
    v_or_b32 v24, v24, v67
    s_waitcnt vmcnt(6)
    v_xor_b32 v68, s64, v68
    v_xor_b32 v69, s65, v69
    v_xor_b32 v70, s66, v70
    v_xor_b32 v71, s87, v71
    v_or3_b32 v24, v24, v68, v69
    v_or3_b32 v24, v24, v70, v71
    v_pk_add_f32 v[64:65], v[64:65], v[68:69]
    v_pk_add_f32 v[66:67], v[66:67], v[70:71]
    s_waitcnt vmcnt(5)
    v_xor_b32 v72, s64, v72
    v_xor_b32 v73, s65, v73
    v_xor_b32 v74, s66, v74
    v_xor_b32 v75, s87, v75
    v_or3_b32 v24, v24, v72, v73
    v_or3_b32 v24, v24, v74, v75
    v_pk_add_f32 v[64:65], v[64:65], v[72:73]
    v_pk_add_f32 v[66:67], v[66:67], v[74:75]
    s_waitcnt vmcnt(4)
    v_xor_b32 v76, s64, v76
    v_xor_b32 v77, s65, v77
    v_xor_b32 v78, s66, v78
    v_xor_b32 v79, s87, v79
    v_or3_b32 v24, v24, v76, v77
    v_or3_b32 v24, v24, v78, v79
    v_pk_add_f32 v[64:65], v[64:65], v[76:77]
    v_pk_add_f32 v[66:67], v[66:67], v[78:79]
    s_waitcnt vmcnt(3)
    v_xor_b32 v80, s64, v80
    v_xor_b32 v81, s65, v81
    v_xor_b32 v82, s66, v82
    v_xor_b32 v83, s87, v83
    v_or3_b32 v24, v24, v80, v81
    v_or3_b32 v24, v24, v82, v83
    v_pk_add_f32 v[64:65], v[64:65], v[80:81]
    v_pk_add_f32 v[66:67], v[66:67], v[82:83]
    s_waitcnt vmcnt(2)
    v_xor_b32 v84, s64, v84
    v_xor_b32 v85, s65, v85
    v_xor_b32 v86, s66, v86
    v_xor_b32 v87, s87, v87
    v_or3_b32 v24, v24, v84, v85
    v_or3_b32 v24, v24, v86, v87
    v_pk_add_f32 v[64:65], v[64:65], v[84:85]
    v_pk_add_f32 v[66:67], v[66:67], v[86:87]
    s_waitcnt vmcnt(1)
    v_xor_b32 v88, s64, v88
    v_xor_b32 v89, s65, v89
    v_xor_b32 v90, s66, v90
    v_xor_b32 v91, s87, v91
    v_or3_b32 v24, v24, v88, v89
    v_or3_b32 v24, v24, v90, v91
    v_pk_add_f32 v[64:65], v[64:65], v[88:89]
    v_pk_add_f32 v[66:67], v[66:67], v[90:91]
    s_waitcnt vmcnt(0)
    v_xor_b32 v92, s64, v92
    v_xor_b32 v93, s65, v93
    v_xor_b32 v94, s66, v94
    v_xor_b32 v95, s87, v95
    v_or3_b32 v24, v24, v92, v93
    v_or3_b32 v24, v24, v94, v95
    v_pk_add_f32 v[64:65], v[64:65], v[92:93]
    v_pk_add_f32 v[66:67], v[66:67], v[94:95]
    v_and_b32 v24, 0xff, v24
    v_cmp_ne_u32 vcc, 0, v24
    s_cbranch_vccz L_gotq
    s_sleep 8
    s_sub_u32 s58, s58, 1
    s_cmp_gt_i32 s58, 0
    s_cbranch_scc1 L_pollq
    s_cmp_lg_u32 s58, 0
    s_cbranch_scc1 L_pollqb
    v_bfi_b32 v48, v3, s64, v48
    v_bfi_b32 v49, v3, s65, v49
    v_bfi_b32 v50, v3, s66, v50
    v_bfi_b32 v51, v3, s67, v51
    global_store_dwordx4 v22, v[48:51], s[28:29] sc1
L_pollqb:
    s_mov_b32 s58, 0
    s_mov_b32 s59, 0
    global_load_dwordx4 v[64:67], v33, s[28:29] offset:-4096 sc1
    global_load_dwordx4 v[68:71], v33, s[28:29] offset:-3072 sc1
    global_load_dwordx4 v[72:75], v33, s[28:29] offset:-2048 sc1
    global_load_dwordx4 v[76:79], v33, s[28:29] offset:-1024 sc1
    global_load_dwordx4 v[80:83], v33, s[28:29] offset:0 sc1
    global_load_dwordx4 v[84:87], v33, s[28:29] offset:1024 sc1
    global_load_dwordx4 v[88:91], v33, s[28:29] offset:2048 sc1
    global_load_dwordx4 v[92:95], v33, s[28:29] offset:3072 sc1
    s_sub_u32 s52, s52, 1
    s_cbranch_scc1 L_gotq
    s_waitcnt vmcnt(7)
    v_xor_b32 v64, s64, v64
    v_xor_b32 v65, s65, v65
    v_xor_b32 v66, s66, v66
    v_xor_b32 v67, s67, v67
    v_or3_b32 v24, v64, v65, v66
    v_or_b32 v24, v24, v67
    s_waitcnt vmcnt(6)
    v_xor_b32 v68, s64, v68
    v_xor_b32 v69, s65, v69
    v_xor_b32 v70, s66, v70
    v_xor_b32 v71, s67, v71
    v_or3_b32 v24, v24, v68, v69
    v_or3_b32 v24, v24, v70, v71
    v_pk_add_f32 v[64:65], v[64:65], v[68:69]
    v_pk_add_f32 v[66:67], v[66:67], v[70:71]
    s_waitcnt vmcnt(5)
    v_xor_b32 v72, s64, v72
    v_xor_b32 v73, s65, v73
    v_xor_b32 v74, s66, v74
    v_xor_b32 v75, s67, v75
    v_or3_b32 v24, v24, v72, v73
    v_or3_b32 v24, v24, v74, v75
    v_pk_add_f32 v[64:65], v[64:65], v[72:73]
    v_pk_add_f32 v[66:67], v[66:67], v[74:75]
    s_waitcnt vmcnt(4)
    v_xor_b32 v76, s64, v76
    v_xor_b32 v77, s65, v77
    v_xor_b32 v78, s66, v78
    v_xor_b32 v79, s67, v79
    v_or3_b32 v24, v24, v76, v77
    v_or3_b32 v24, v24, v78, v79
    v_pk_add_f32 v[64:65], v[64:65], v[76:77]
    v_pk_add_f32 v[66:67], v[66:67], v[78:79]
    s_waitcnt vmcnt(3)
    v_xor_b32 v80, s64, v80
    v_xor_b32 v81, s65, v81
    v_xor_b32 v82, s66, v82
    v_xor_b32 v83, s67, v83
    v_or3_b32 v24, v24, v80, v81
    v_or3_b32 v24, v24, v82, v83
    v_pk_add_f32 v[64:65], v[64:65], v[80:81]
    v_pk_add_f32 v[66:67], v[66:67], v[82:83]
    s_waitcnt vmcnt(2)
    v_xor_b32 v84, s64, v84
    v_xor_b32 v85, s65, v85
    v_xor_b32 v86, s66, v86
    v_xor_b32 v87, s67, v87
    v_or3_b32 v24, v24, v84, v85
    v_or3_b32 v24, v24, v86, v87
    v_pk_add_f32 v[64:65], v[64:65], v[84:85]
    v_pk_add_f32 v[66:67], v[66:67], v[86:87]
    s_waitcnt vmcnt(1)
    v_xor_b32 v88, s64, v88
    v_xor_b32 v89, s65, v89
    v_xor_b32 v90, s66, v90
    v_xor_b32 v91, s67, v91
    v_or3_b32 v24, v24, v88, v89
    v_or3_b32 v24, v24, v90, v91
    v_pk_add_f32 v[64:65], v[64:65], v[88:89]
    v_pk_add_f32 v[66:67], v[66:67], v[90:91]
    s_waitcnt vmcnt(0)
    v_xor_b32 v92, s64, v92
    v_xor_b32 v93, s65, v93
    v_xor_b32 v94, s66, v94
    v_xor_b32 v95, s67, v95
    v_or3_b32 v24, v24, v92, v93
    v_or3_b32 v24, v24, v94, v95
    v_pk_add_f32 v[64:65], v[64:65], v[92:93]
    v_pk_add_f32 v[66:67], v[66:67], v[94:95]
    v_and_b32 v24, 0xff, v24
    v_cmp_ne_u32 vcc, 0, v24
    s_cbranch_vccnz L_pollq
L_gotq:
    s_max_i32 s52, s52, 0
    s_waitcnt vmcnt(0)
    v_cvt_pk_bf16_f32 v64, v64, v65
    v_cvt_pk_bf16_f32 v65, v66, v67
    v_mov_b32 v22, s59
    ds_write_b64 v21, v[64:65] offset:0
    ds_write_b32 v23, v22 offset:768
    s_branch L_wo
L_s123b:
    s_waitcnt vmcnt(0)
    v_lshlrev_b32 v84, 16, v64
    v_and_b32 v85, s39, v64
    v_lshlrev_b32 v96, 16, v70
    v_and_b32 v97, s39, v70
    v_lshlrev_b32 v86, 16, v65
    v_and_b32 v87, s39, v65
    v_lshlrev_b32 v98, 16, v71
    v_and_b32 v99, s39, v71
    v_lshlrev_b32 v88, 16, v66
    v_and_b32 v89, s39, v66
    v_lshlrev_b32 v100, 16, v72
    v_and_b32 v101, s39, v72
    v_lshlrev_b32 v90, 16, v67
    v_and_b32 v91, s39, v67
    v_lshlrev_b32 v102, 16, v73
    v_and_b32 v103, s39, v73
    v_lshlrev_b32 v92, 16, v68
    v_and_b32 v93, s39, v68
    v_lshlrev_b32 v104, 16, v74
    v_and_b32 v105, s39, v74
    v_lshlrev_b32 v94, 16, v69
    v_and_b32 v95, s39, v69
    v_lshlrev_b32 v106, 16, v75
    v_and_b32 v107, s39, v75
    s_lshr_b32 s3, s35, 1
    s_mul_i32 s3, s3, 18
    s_mul_i32 s36, s32, 1152
    s_add_u32 s3, s3, s36
    s_add_u32 s3, s3, s54
    v_mov_b32 v21, s3
    ds_read_u16 v22, v21
    s_lshl_b32 s3, s37, 6
    s_add_u32 s3, s3, 512
    v_mov_b32 v20, s3
    v_mov_b32 v24, 0xc0135761
    v_mov_b32 v25, 0xbdd2d3e8
    v_mov_b32 v26, 1.0
    s_mov_b32 s38, 9
L_gl:
    s_waitcnt lgkmcnt(0)
    v_lshlrev_b32 v28, 16, v22
    v_add_u32 v21, 2, v21
    ds_read_u16 v22, v21
    v_pk_mul_f32 v[108:109], v[84:85], v[28:29] op_sel_hi:[1,0]
    v_pk_mul_f32 v[110:111], v[86:87], v[28:29] op_sel_hi:[1,0]
    v_pk_mul_f32 v[112:113], v[88:89], v[28:29] op_sel_hi:[1,0]
    v_pk_mul_f32 v[114:115], v[90:91], v[28:29] op_sel_hi:[1,0]
    v_pk_mul_f32 v[116:117], v[92:93], v[28:29] op_sel_hi:[1,0]
    v_pk_mul_f32 v[118:119], v[94:95], v[28:29] op_sel_hi:[1,0]
    v_cvt_pk_bf16_f32 v30, v108, v109
    v_cvt_pk_bf16_f32 v31, v110, v111
    v_cvt_pk_bf16_f32 v32, v112, v113
    v_cvt_pk_bf16_f32 v33, v114, v115
    v_cvt_pk_bf16_f32 v34, v116, v117
    v_cvt_pk_bf16_f32 v35, v118, v119
    v_lshlrev_b32 v108, 16, v30
    v_and_b32 v109, s39, v30
    v_lshlrev_b32 v110, 16, v31
    v_and_b32 v111, s39, v31
    v_lshlrev_b32 v112, 16, v32
    v_and_b32 v113, s39, v32
    v_lshlrev_b32 v114, 16, v33
    v_and_b32 v115, s39, v33
    v_lshlrev_b32 v116, 16, v34
    v_and_b32 v117, s39, v34
    v_lshlrev_b32 v118, 16, v35
    v_and_b32 v119, s39, v35
    v_pk_add_f32 v[108:109], v[108:109], v[96:97]
    v_pk_add_f32 v[110:111], v[110:111], v[98:99]
    v_pk_add_f32 v[112:113], v[112:113], v[100:101]
    v_pk_add_f32 v[114:115], v[114:115], v[102:103]
    v_pk_add_f32 v[116:117], v[116:117], v[104:105]
    v_pk_add_f32 v[118:119], v[118:119], v[106:107]
    v_cvt_pk_bf16_f32 v30, v108, v109
    v_cvt_pk_bf16_f32 v31, v110, v111
    v_cvt_pk_bf16_f32 v32, v112, v113
    v_cvt_pk_bf16_f32 v33, v114, v115
    v_cvt_pk_bf16_f32 v34, v116, v117
    v_cvt_pk_bf16_f32 v35, v118, v119
    v_lshlrev_b32 v108, 16, v30
    v_and_b32 v109, s39, v30
    v_lshlrev_b32 v110, 16, v31
    v_and_b32 v111, s39, v31
    v_lshlrev_b32 v112, 16, v32
    v_and_b32 v113, s39, v32
    v_lshlrev_b32 v114, 16, v33
    v_and_b32 v115, s39, v33
    v_lshlrev_b32 v116, 16, v34
    v_and_b32 v117, s39, v34
    v_lshlrev_b32 v118, 16, v35
    v_and_b32 v119, s39, v35
    v_pk_mul_f32 v[120:121], v[108:109], v[108:109]
    v_pk_mul_f32 v[122:123], v[110:111], v[110:111]
    v_pk_mul_f32 v[124:125], v[112:113], v[112:113]
    v_pk_mul_f32 v[126:127], v[114:115], v[114:115]
    v_pk_mul_f32 v[128:129], v[116:117], v[116:117]
    v_pk_mul_f32 v[130:131], v[118:119], v[118:119]
    v_pk_fma_f32 v[120:121], v[120:121], v[24:25], v[24:25] op_sel:[0,1,0] op_sel_hi:[1,1,0]
    v_pk_fma_f32 v[122:123], v[122:123], v[24:25], v[24:25] op_sel:[0,1,0] op_sel_hi:[1,1,0]
    v_pk_fma_f32 v[124:125], v[124:125], v[24:25], v[24:25] op_sel:[0,1,0] op_sel_hi:[1,1,0]
    v_pk_fma_f32 v[126:127], v[126:127], v[24:25], v[24:25] op_sel:[0,1,0] op_sel_hi:[1,1,0]
    v_pk_fma_f32 v[128:129], v[128:129], v[24:25], v[24:25] op_sel:[0,1,0] op_sel_hi:[1,1,0]
    v_pk_fma_f32 v[130:131], v[130:131], v[24:25], v[24:25] op_sel:[0,1,0] op_sel_hi:[1,1,0]
    v_pk_mul_f32 v[120:121], v[120:121], v[108:109]
    v_pk_mul_f32 v[122:123], v[122:123], v[110:111]
    v_pk_mul_f32 v[124:125], v[124:125], v[112:113]
    v_pk_mul_f32 v[126:127], v[126:127], v[114:115]
    v_pk_mul_f32 v[128:129], v[128:129], v[116:117]
    v_pk_mul_f32 v[130:131], v[130:131], v[118:119]
    v_exp_f32 v120, v120
    v_exp_f32 v121, v121
    v_exp_f32 v122, v122
    v_exp_f32 v123, v123
    v_exp_f32 v124, v124
    v_exp_f32 v125, v125
    v_exp_f32 v126, v126
    v_exp_f32 v127, v127
    v_exp_f32 v128, v128
    v_exp_f32 v129, v129
    v_exp_f32 v130, v130
    v_exp_f32 v131, v131
    v_pk_add_f32 v[120:121], v[120:121], v[26:27] op_sel_hi:[1,0]
    v_pk_add_f32 v[122:123], v[122:123], v[26:27] op_sel_hi:[1,0]
    v_pk_add_f32 v[124:125], v[124:125], v[26:27] op_sel_hi:[1,0]
    v_pk_add_f32 v[126:127], v[126:127], v[26:27] op_sel_hi:[1,0]
    v_pk_add_f32 v[128:129], v[128:129], v[26:27] op_sel_hi:[1,0]
    v_pk_add_f32 v[130:131], v[130:131], v[26:27] op_sel_hi:[1,0]
    v_rcp_f32 v120, v120
    v_rcp_f32 v121, v121
    v_rcp_f32 v122, v122
    v_rcp_f32 v123, v123
    v_rcp_f32 v124, v124
    v_rcp_f32 v125, v125
    v_rcp_f32 v126, v126
    v_rcp_f32 v127, v127
    v_rcp_f32 v128, v128
    v_rcp_f32 v129, v129
    v_rcp_f32 v130, v130
    v_rcp_f32 v131, v131
    v_pk_mul_f32 v[120:121], v[120:121], v[108:109]
    v_pk_mul_f32 v[122:123], v[122:123], v[110:111]
    v_pk_mul_f32 v[124:125], v[124:125], v[112:113]
    v_pk_mul_f32 v[126:127], v[126:127], v[114:115]
    v_pk_mul_f32 v[128:129], v[128:129], v[116:117]
    v_pk_mul_f32 v[130:131], v[130:131], v[118:119]
    v_cvt_pk_bf16_f32 v30, v120, v121
    v_cvt_pk_bf16_f32 v31, v122, v123
    v_cvt_pk_bf16_f32 v32, v124, v125
    v_cvt_pk_bf16_f32 v33, v126, v127
    v_cvt_pk_bf16_f32 v34, v128, v129
    v_cvt_pk_bf16_f32 v35, v130, v131
    v_dot2_f32_bf16 v36, v30, v76, 0
    v_dot2_f32_bf16 v36, v31, v77, v36
    v_dot2_f32_bf16 v36, v32, v78, v36
    v_dot2_f32_bf16 v36, v33, v79, v36
    v_dot2_f32_bf16 v36, v34, v80, v36
    v_dot2_f32_bf16 v36, v35, v81, v36
    s_nop 2
    v_add_f32_dpp v36, v36, v36 quad_perm:[1,0,3,2] row_mask:0xf bank_mask:0xf
    s_nop 1
    v_add_f32_dpp v36, v36, v36 quad_perm:[2,3,0,1] row_mask:0xf bank_mask:0xf
    s_nop 1
    v_add_f32_dpp v36, v36, v36 row_half_mirror row_mask:0xf bank_mask:0xf
    s_nop 1
    v_add_f32_dpp v36, v36, v36 row_mirror row_mask:0xf bank_mask:0xf
    v_mov_b32 v37, v36
    s_nop 1
    v_permlane16_swap_b32 v36, v37
    v_add_f32 v36, v36, v37
    v_mov_b32 v37, v36
    s_nop 1
    v_permlane32_swap_b32 v36, v37
    v_add_f32 v36, v36, v37
    s_mov_b64 exec, 1
    ds_write_b32 v20, v36
    s_mov_b64 exec, -1
    v_add_u32 v20, 4, v20
    s_sub_u32 s38, s38, 1
    s_cmp_lg_u32 s38, 0
    s_cbranch_scc1 L_gl
L_gelx:
    s_load_dword s60, s[26:27], 0
    v_and_b32 v21, 1, v0
    v_cmp_eq_u32 vcc, 1, v21
    v_mov_b32 v21, 0x0c0c0100
    v_mov_b32 v22, 0x01000c0c
    v_cndmask_b32 v139, v21, v22, vcc
    v_mov_b32 v21, 0x0c0c0302
    v_mov_b32 v22, 0x03020c0c
    v_cndmask_b32 v143, v21, v22, vcc
    v_bfe_u32 v21, v0, 1, 2
    v_mov_b32 v22, 0x0c0c0c0c
    v_cmp_eq_u32 vcc, 0, v21
    s_nop 1
    v_cndmask_b32 v136, v22, v139, vcc
    v_cndmask_b32 v140, v22, v143, vcc
    v_cmp_eq_u32 vcc, 1, v21
    s_nop 1
    v_cndmask_b32 v137, v22, v139, vcc
    v_cndmask_b32 v141, v22, v143, vcc
    v_cmp_eq_u32 vcc, 2, v21
    s_nop 1
    v_cndmask_b32 v138, v22, v139, vcc
    v_cndmask_b32 v142, v22, v143, vcc
    v_cmp_eq_u32 vcc, 3, v21
    s_nop 1
    v_cndmask_b32 v139, v22, v139, vcc
    v_cndmask_b32 v143, v22, v143, vcc
    s_waitcnt lgkmcnt(0)
    s_cmp_lg_u32 s60, 0
    s_cbranch_scc1 L_gnb
L_pnb:
    global_load_dword v21, v23, s[26:27] sc1
    s_sub_u32 s52, s52, 1
    s_cbranch_scc1 L_gnb
    s_waitcnt vmcnt(0)
    v_readfirstlane_b32 s60, v21
    s_sleep 8
    s_cmp_eq_u32 s60, 0
    s_cbranch_scc1 L_pnb
L_gnb:
    s_max_i32 s52, s52, 0
    s_and_b32 s64, s60, 0xff
    s_bfe_u32 s65, s60, 0x80008
    s_bfe_u32 s66, s60, 0x80010
    s_lshr_b32 s67, s60, 24
    s_getreg_b32 s87, hwreg(HW_REG_XCC_ID, 0, 4)
    s_xor_b32 s87, s87, s67
    s_add_u32 s62, s28, 2097152
    s_addc_u32 s63, s29, 0
    s_setprio 1
L_wo:
    s_mov_b32 s40, s12
    s_mov_b32 s41, s13
    s_mul_i32 s48, s35, 36864
    s_lshl_b32 s3, s37, 8
    s_add_u32 s48, s48, s3
    v_bfe_u32 v16, v0, 3, 1
    v_lshl_add_u32 v16, v16, 2, v15
    v_lshlrev_b32 v19, 4, v16
    v_mul_u32_u24 v16, 4608, v16
    v_and_b32 v17, 7, v0
    v_lshl_add_u32 v16, v17, 4, v16
    v_lshl_add_u32 v19, v17, 7, v19
    s_lshl_b32 s3, s34, 13
    s_lshl_b32 s36, s33, 10
    s_add_u32 s3, s3, s36
    s_add_u32 s3, s3, 294912
    v_add_u32 v19, s3, v19
    s_mul_i32 s3, s32, 294912
    s_lshl_b32 s36, s35, 7
    s_add_u32 s3, s3, s36
    s_lshl_b32 s36, s37, 16
    s_add_u32 s3, s3, s36
    s_add_u32 s3, s3, 557056
    v_lshrrev_b32 v18, 2, v17
    v_lshl_add_u32 v18, v13, 1, v18
    v_lshlrev_b32 v18, 14, v18
    v_and_b32 v21, 3, v0
    v_lshl_add_u32 v18, v21, 5, v18
    v_and_b32 v21, 1, v15
    v_lshl_add_u32 v18, v21, 4, v18
    v_add_u32 v18, s3, v18
    s_lshl_b32 s3, s2, 2
    s_add_u32 s3, s3, s37
    s_lshl_b32 s3, s3, 12
    s_add_u32 s3, s3, 557056
    v_lshl_add_u32 v55, v0, 4, s3
    s_lshl_b32 s3, s37, 8
    v_lshl_add_u32 v60, v0, 2, s3
    s_cmp_eq_u32 s37, 1
    s_cbranch_scc1 L_s1g
    s_cmp_eq_u32 s37, 2
    s_cbranch_scc1 L_s2g
    s_cmp_eq_u32 s37, 0
    s_cbranch_scc1 L_s0s
L_wmt:
    ds_read_b32 v24, v23 offset:776
    s_sub_u32 s52, s52, 1
    s_cbranch_scc1 L_gmt
    s_waitcnt lgkmcnt(0)
    v_cmp_gt_i32 vcc, 3, v24
    s_sleep 1
    s_cbranch_vccnz L_wmt
L_gmt:
    s_max_i32 s52, s52, 0
    s_waitcnt lgkmcnt(0)
    global_load_dwordx4 v[208:211], v19, s[62:63] nt
    buffer_load_dwordx4 v[176:179], v16, s[40:43], s48 offen offset:256 nt
    buffer_load_dwordx4 v[180:183], v16, s[40:43], s48 offen offset:1408 nt
    buffer_load_dwordx4 v[184:187], v16, s[40:43], s48 offen offset:2560 nt
    buffer_load_dwordx4 v[188:191], v16, s[40:43], s48 offen offset:3712 nt
    s_branch L_b3w
L_s0s:
    v_lshrrev_b32 v21, 1, v15
    v_lshrrev_b32 v22, 2, v14
    v_lshl_add_u32 v21, v21, 2, v22
    v_and_b32 v22, 3, v14
    v_lshlrev_b32 v22, 5, v22
    v_lshl_add_u32 v20, v21, 10, v22
    v_and_b32 v22, 1, v15
    v_lshl_add_u32 v20, v22, 4, v20
    s_lshl_b32 s3, s34, 13
    s_lshl_b32 s36, s33, 7
    s_add_u32 s3, s3, s36
    s_add_u32 s3, s3, 294912
    v_add_u32 v20, s3, v20
    v_lshlrev_b32 v21, 3, v13
    s_lshl_b32 s53, s34, 8
    s_add_u32 s53, s53, 262144
    v_lshlrev_b32 v22, 4, v13
    v_lshl_add_u32 v45, v17, 5, v22
    v_add_u32 v45, s53, v45
    s_lshl_b32 s36, s33, 5
    s_add_u32 s3, s53, s36
    v_add_u32 v22, s3, v22
L_pls:
    ds_read_b64 v[24:25], v21 offset:512
    ds_read_b64 v[26:27], v21 offset:528
    ds_read_b64 v[28:29], v21 offset:544
    ds_read_b64 v[30:31], v21 offset:560
    s_sub_u32 s52, s52, 1
    s_cbranch_scc1 L_gls
    s_waitcnt lgkmcnt(0)
    v_max3_u32 v32, v24, v25, v26
    v_max3_u32 v32, v32, v27, v28
    v_max3_u32 v32, v32, v29, v30
    v_max_u32 v32, v32, v31
    v_cmp_eq_u32 vcc, -1, v32
    s_sleep 4
    s_cbranch_vccnz L_pls
L_gls:
    s_max_i32 s52, s52, 0
    s_waitcnt lgkmcnt(0)
    v_mov_b32 v56, v24
    v_mov_b32 v57, v26
    v_mov_b32 v58, v28
    v_mov_b32 v59, v30
    v_max3_f32 v32, v24, v26, v28
    v_max_f32 v32, v32, v30
    v_sub_f32 v36, v24, v32
    v_mul_f32 v36, s51, v36
    v_exp_f32 v36, v36
    v_sub_f32 v37, v26, v32
    v_mul_f32 v37, s51, v37
    v_exp_f32 v37, v37
    v_sub_f32 v38, v28, v32
    v_mul_f32 v38, s51, v38
    v_exp_f32 v38, v38
    v_sub_f32 v39, v30, v32
    v_mul_f32 v39, s51, v39
    v_exp_f32 v39, v39
    v_mul_f32 v33, v36, v25
    v_fmac_f32 v33, v37, v27
    v_fmac_f32 v33, v38, v29
    v_fmac_f32 v33, v39, v31
    v_add_u32 v33, 0x80, v33
    v_mov_b32 v34, 0
    v_mov_b32 v35, 0
    s_mov_b32 exec_lo, 1
    s_mov_b32 exec_hi, 1
    s_cmp_lg_u32 s59, 0
    s_cbranch_scc1 L_stl
    v_bfi_b32 v32, v3, s64, v32
    v_bfi_b32 v33, v3, s65, v33
    v_bfi_b32 v34, v3, s66, v34
    v_bfi_b32 v35, v3, s67, v35
    global_store_dwordx4 v22, v[32:35], s[28:29] sc1
    s_nop 1
L_stl:
    v_bfi_b32 v32, v3, s64, v32
    v_bfi_b32 v33, v3, s65, v33
    v_bfi_b32 v34, v3, s66, v34
    v_bfi_b32 v35, v3, s87, v35
    global_store_dwordx4 v22, v[32:35], s[62:63]
    s_mov_b64 exec, -1
L_wms:
    ds_read_b32 v24, v23 offset:772
    s_sub_u32 s52, s52, 1
    s_cbranch_scc1 L_gms
    s_waitcnt lgkmcnt(0)
    v_cmp_gt_i32 vcc, 2, v24
    s_sleep 4
    s_cbranch_vccnz L_wms
L_gms:
    s_max_i32 s52, s52, 0
    s_waitcnt lgkmcnt(0)
L_pst:
    global_load_dwordx4 v[36:39], v45, s[62:63] nt
    s_sub_u32 s52, s52, 1
    s_cbranch_scc1 L_gst
    s_waitcnt vmcnt(0)
    v_xor_b32 v36, s64, v36
    v_xor_b32 v37, s65, v37
    v_xor_b32 v38, s66, v38
    v_xor_b32 v39, s87, v39
    v_or3_b32 v40, v36, v37, v38
    v_or_b32 v40, v40, v39
    v_and_b32 v40, 0xff, v40
    v_cmp_ne_u32 vcc, 0, v40
    s_cbranch_vccz L_gst
    s_sleep 8
    s_cmp_lg_u32 s59, 0
    s_cbranch_scc1 L_pst
    global_load_dwordx4 v[36:39], v45, s[28:29] sc1
    s_waitcnt vmcnt(0)
    v_xor_b32 v36, s64, v36
    v_xor_b32 v37, s65, v37
    v_xor_b32 v38, s66, v38
    v_xor_b32 v39, s67, v39
    v_or3_b32 v40, v36, v37, v38
    v_or_b32 v40, v40, v39
    v_and_b32 v40, 0xff, v40
    v_cmp_ne_u32 vcc, 0, v40
    s_cbranch_vccnz L_pst
L_gst:
    s_max_i32 s52, s52, 0
    s_waitcnt vmcnt(0)
    v_mov_b32 v40, v36
    s_nop 1
    v_max_f32_dpp v40, v40, v40 quad_perm:[1,0,3,2] row_mask:0xf bank_mask:0xf
    s_nop 1
    v_max_f32_dpp v40, v40, v40 quad_perm:[2,3,0,1] row_mask:0xf bank_mask:0xf
    s_nop 1
    v_max_f32_dpp v40, v40, v40 row_half_mirror row_mask:0xf bank_mask:0xf
    v_sub_f32 v36, v36, v40
    v_mul_f32 v36, s51, v36
    v_exp_f32 v36, v36
    s_nop 0
    v_mul_f32 v36, v36, v37
    s_nop 1
    v_add_f32_dpp v36, v36, v36 quad_perm:[1,0,3,2] row_mask:0xf bank_mask:0xf
    s_nop 1
    v_add_f32_dpp v36, v36, v36 quad_perm:[2,3,0,1] row_mask:0xf bank_mask:0xf
    s_nop 1
    v_add_f32_dpp v36, v36, v36 row_half_mirror row_mask:0xf bank_mask:0xf
    v_rcp_f32 v36, v36
    v_sub_f32 v48, v56, v40
    v_mul_f32 v48, s51, v48
    v_exp_f32 v48, v48
    v_sub_f32 v49, v57, v40
    v_mul_f32 v49, s51, v49
    v_exp_f32 v49, v49
    v_sub_f32 v50, v58, v40
    v_mul_f32 v50, s51, v50
    v_exp_f32 v50, v50
    v_sub_f32 v51, v59, v40
    v_mul_f32 v51, s51, v51
    v_exp_f32 v51, v51
    v_mul_f32 v48, v48, v36
    v_mul_f32 v49, v49, v36
    v_mul_f32 v50, v50, v36
    v_mul_f32 v51, v51, v36
    v_lshlrev_b32 v21, 4, v0
L_wmu:
    ds_read_b32 v24, v23 offset:776
    s_sub_u32 s52, s52, 1
    s_cbranch_scc1 L_gmu
    s_waitcnt lgkmcnt(0)
    v_cmp_gt_i32 vcc, 3, v24
    s_sleep 1
    s_cbranch_vccnz L_wmu
L_gmu:
    s_max_i32 s52, s52, 0
    s_waitcnt lgkmcnt(0)
    buffer_load_dwordx4 v[144:147], v16, s[40:43], s48 offen offset:0 nt
    buffer_load_dwordx4 v[148:151], v16, s[40:43], s48 offen offset:1152 nt
    buffer_load_dwordx4 v[152:155], v16, s[40:43], s48 offen offset:2304 nt
    buffer_load_dwordx4 v[156:159], v16, s[40:43], s48 offen offset:3456 nt
    buffer_load_dwordx4 v[160:163], v16, s[40:43], s48 offen offset:128 nt
    buffer_load_dwordx4 v[164:167], v16, s[40:43], s48 offen offset:1280 nt
    buffer_load_dwordx4 v[168:171], v16, s[40:43], s48 offen offset:2432 nt
    buffer_load_dwordx4 v[172:175], v16, s[40:43], s48 offen offset:3584 nt
    s_cmp_lg_u32 s59, 0
    s_barrier
    ds_read_b128 v[24:27], v21 offset:1024
    ds_read_b128 v[28:31], v21 offset:2048
    ds_read_b128 v[32:35], v21 offset:3072
    ds_read_b128 v[36:39], v21 offset:4096
    s_waitcnt lgkmcnt(3)
    v_pk_mul_f32 v[44:45], v[24:25], v[48:49] op_sel_hi:[1,0]
    v_pk_mul_f32 v[46:47], v[26:27], v[48:49] op_sel_hi:[1,0]
    s_waitcnt lgkmcnt(2)
    v_pk_fma_f32 v[44:45], v[28:29], v[48:49], v[44:45] op_sel:[0,1,0] op_sel_hi:[1,1,1]
    v_pk_fma_f32 v[46:47], v[30:31], v[48:49], v[46:47] op_sel:[0,1,0] op_sel_hi:[1,1,1]
    s_waitcnt lgkmcnt(1)
    v_pk_fma_f32 v[44:45], v[32:33], v[50:51], v[44:45] op_sel:[0,0,0] op_sel_hi:[1,0,1]
    v_pk_fma_f32 v[46:47], v[34:35], v[50:51], v[46:47] op_sel:[0,0,0] op_sel_hi:[1,0,1]
    s_waitcnt lgkmcnt(0)
    v_pk_fma_f32 v[44:45], v[36:37], v[50:51], v[44:45] op_sel:[0,1,0] op_sel_hi:[1,1,1]
    v_pk_fma_f32 v[46:47], v[38:39], v[50:51], v[46:47] op_sel:[0,1,0] op_sel_hi:[1,1,1]
    s_cbranch_scc1 L_x1loc
    v_bfi_b32 v44, v3, s64, v44
    v_bfi_b32 v45, v3, s65, v45
    v_bfi_b32 v46, v3, s66, v46
    v_bfi_b32 v47, v3, s67, v47
    global_store_dwordx4 v20, v[44:47], s[28:29] sc1
    s_nop 1
L_x1loc:
    v_bfi_b32 v44, v3, s64, v44
    v_bfi_b32 v45, v3, s65, v45
    v_bfi_b32 v46, v3, s66, v46
    v_bfi_b32 v47, v3, s87, v47
    global_store_dwordx4 v20, v[44:47], s[62:63]
    s_branch L_stage2
L_s2g:
    v_lshlrev_b32 v21, 4, v0
    s_lshl_b32 s3, s32, 1
    s_and_b32 s36, s35, 1
    s_add_u32 s3, s3, s36
    s_lshl_b32 s3, s3, 6
    s_lshr_b32 s36, s35, 1
    s_add_u32 s3, s3, s36
    s_lshl_b32 s3, s3, 6
    s_add_u32 s3, s3, 1146880
    v_add_u32 v22, s3, v21
    s_mov_b64 exec, 7
L_plg:
    ds_read_b128 v[24:27], v21 offset:576
    ds_read_b128 v[28:31], v21 offset:640
    ds_read_b128 v[32:35], v21 offset:704
    s_sub_u32 s52, s52, 1
    s_cbranch_scc1 L_glg
    s_waitcnt lgkmcnt(0)
    v_max3_u32 v36, v24, v25, v26
    v_max3_u32 v36, v36, v27, v28
    v_max3_u32 v36, v36, v29, v30
    v_max3_u32 v36, v36, v31, v32
    v_max3_u32 v36, v36, v33, v34
    v_max_u32 v36, v36, v35
    v_cmp_eq_u32 vcc, -1, v36
    s_sleep 4
    s_cbranch_vccnz L_plg
L_glg:
    s_max_i32 s52, s52, 0
    s_waitcnt lgkmcnt(0)
    v_pk_add_f32 v[24:25], v[24:25], v[28:29]
    v_pk_add_f32 v[26:27], v[26:27], v[30:31]
    v_pk_add_f32 v[24:25], v[24:25], v[32:33]
    v_pk_add_f32 v[26:27], v[26:27], v[34:35]
    v_add_u32 v24, 0x80, v24
    v_add_u32 v25, 0x80, v25
    v_add_u32 v26, 0x80, v26
    v_add_u32 v27, 0x80, v27
    v_bfi_b32 v24, v3, s64, v24
    v_bfi_b32 v25, v3, s65, v25
    v_bfi_b32 v26, v3, s66, v26
    v_bfi_b32 v27, v3, s67, v27
    global_store_dwordx4 v22, v[24:27], s[28:29] sc1 nt
    s_mov_b64 exec, -1
    s_branch L_b3
L_s1g:
    s_cmp_ge_u32 s2, 36
    s_cbranch_scc1 L_b3
    s_cmp_ge_u32 s2, 18
    s_cselect_b32 s56, 576, 0
    s_cselect_b32 s3, 18, 0
    s_sub_u32 s57, s2, s3
    s_lshl_b32 s57, s57, 5
    s_cmp_ge_u32 s2, 18
    v_lshl_add_u32 v21, v17, 2, v15
    v_add_u32 v21, s57, v21
    v_add_u32 v52, s56, v21
    v_lshlrev_b32 v52, 1, v52
    global_load_ushort v53, v52, s[4:5]
    global_load_ushort v54, v23, s[22:23]
    s_cselect_b32 s3, 8192, 0
    s_add_u32 s3, s3, 1146880
    v_mul_u32_u24 v22, 7282, v21
    v_lshrrev_b32 v22, 16, v22
    v_mul_u32_u24 v33, 9, v22
    v_sub_u32 v33, v21, v33
    v_lshrrev_b32 v21, 2, v33
    v_lshlrev_b32 v21, 4, v21
    v_lshl_add_u32 v21, v22, 6, v21
    v_add_u32 v21, s3, v21
    v_add_u32 v22, 4096, v21
L_wmg:
    ds_read_b32 v24, v23 offset:772
    s_sub_u32 s52, s52, 1
    s_cbranch_scc1 L_gmg
    s_waitcnt lgkmcnt(0)
    v_cmp_gt_i32 vcc, 2, v24
    s_sleep 4
    s_cbranch_vccnz L_wmg
L_gmg:
    s_max_i32 s52, s52, 0
    s_waitcnt lgkmcnt(0)
L_pgp:
    global_load_dwordx4 v[24:27], v21, s[28:29] sc1
    global_load_dwordx4 v[28:31], v22, s[28:29] sc1
    s_sub_u32 s52, s52, 1
    s_cbranch_scc1 L_ggp
    s_waitcnt vmcnt(0)
    v_xor_b32 v24, s64, v24
    v_xor_b32 v25, s65, v25
    v_xor_b32 v26, s66, v26
    v_xor_b32 v27, s67, v27
    v_or3_b32 v32, v24, v25, v26
    v_or_b32 v32, v32, v27
    v_xor_b32 v28, s64, v28
    v_xor_b32 v29, s65, v29
    v_xor_b32 v30, s66, v30
    v_xor_b32 v31, s67, v31
    v_or3_b32 v32, v32, v28, v29
    v_or3_b32 v32, v32, v30, v31
    v_and_b32 v32, 0xff, v32
    v_cmp_ne_u32 vcc, 0, v32
    s_cbranch_vccz L_ggp
    s_sleep 8
    s_branch L_pgp
L_ggp:
    s_max_i32 s52, s52, 0
    s_waitcnt vmcnt(0)
    v_pk_add_f32 v[24:25], v[24:25], v[28:29]
    v_pk_add_f32 v[26:27], v[26:27], v[30:31]
    v_and_b32 v34, 1, v33
    v_cmp_eq_u32 vcc, 1, v34
    v_and_b32 v34, 2, v33
    s_nop 0
    v_cndmask_b32 v24, v24, v25, vcc
    v_cndmask_b32 v26, v26, v27, vcc
    v_cmp_eq_u32 vcc, 2, v34
    s_nop 1
    v_cndmask_b32 v24, v24, v26, vcc
    v_cvt_pk_bf16_f32 v24, v24, v24
    v_lshlrev_b32 v24, 16, v24
    v_lshlrev_b32 v54, 16, v54
    v_add_f32 v24, v24, v54
    v_cvt_pk_bf16_f32 v24, v24, v24
    v_lshlrev_b32 v24, 16, v24
    v_mul_f32 v25, s51, v24
    v_exp_f32 v25, -v25
    s_nop 0
    v_add_f32 v25, 1.0, v25
    v_rcp_f32 v25, v25
    s_nop 0
    v_mul_f32 v54, v24, v25
    v_cvt_pk_bf16_f32 v54, v54, v54
    v_lshlrev_b32 v54, 16, v54
    v_lshlrev_b32 v53, 16, v53
L_b3:
L_wmv:
    ds_read_b32 v24, v23 offset:776
    s_sub_u32 s52, s52, 1
    s_cbranch_scc1 L_gmv
    s_waitcnt lgkmcnt(0)
    v_cmp_gt_i32 vcc, 3, v24
    s_sleep 1
    s_cbranch_vccnz L_wmv
L_gmv:
    s_max_i32 s52, s52, 0
    s_waitcnt lgkmcnt(0)
L_b3w:
    ds_read_b32 v24, v23 offset:768
    buffer_load_dwordx4 v[144:147], v16, s[40:43], s48 offen offset:0 nt
    buffer_load_dwordx4 v[148:151], v16, s[40:43], s48 offen offset:1152 nt
    buffer_load_dwordx4 v[152:155], v16, s[40:43], s48 offen offset:2304 nt
    buffer_load_dwordx4 v[156:159], v16, s[40:43], s48 offen offset:3456 nt
    buffer_load_dwordx4 v[160:163], v16, s[40:43], s48 offen offset:128 nt
    buffer_load_dwordx4 v[164:167], v16, s[40:43], s48 offen offset:1280 nt
    buffer_load_dwordx4 v[168:171], v16, s[40:43], s48 offen offset:2432 nt
    buffer_load_dwordx4 v[172:175], v16, s[40:43], s48 offen offset:3584 nt
    s_waitcnt lgkmcnt(0)
    v_readfirstlane_b32 s59, v24
    s_barrier
L_b4:
L_stage2:
L_px1:
    global_load_dwordx4 v[24:27], v19, s[62:63] nt
    s_sub_u32 s52, s52, 1
    s_cbranch_scc1 L_gx1
    s_waitcnt vmcnt(0)
    v_xor_b32 v24, s64, v24
    v_xor_b32 v25, s65, v25
    v_xor_b32 v26, s66, v26
    v_xor_b32 v27, s87, v27
    v_or3_b32 v28, v24, v25, v26
    v_or_b32 v28, v28, v27
    v_and_b32 v28, 0xff, v28
    v_cmp_ne_u32 vcc, 0, v28
    s_cbranch_vccz L_gx1
    s_cmp_lg_u32 s59, 0
    s_cbranch_scc1 L_px1
    global_load_dwordx4 v[24:27], v19, s[28:29] sc1
    s_waitcnt vmcnt(0)
    v_xor_b32 v24, s64, v24
    v_xor_b32 v25, s65, v25
    v_xor_b32 v26, s66, v26
    v_xor_b32 v27, s67, v27
    v_or3_b32 v28, v24, v25, v26
    v_or_b32 v28, v28, v27
    v_and_b32 v28, 0xff, v28
    v_cmp_ne_u32 vcc, 0, v28
    s_cbranch_vccnz L_px1
L_gx1:
    s_max_i32 s52, s52, 0
    s_waitcnt vmcnt(0)
    v_add_f32_dpp v24, v24, v24 quad_perm:[1,0,3,2] row_mask:0xf bank_mask:0xf
    v_add_f32_dpp v25, v25, v25 quad_perm:[1,0,3,2] row_mask:0xf bank_mask:0xf
    v_add_f32_dpp v26, v26, v26 quad_perm:[1,0,3,2] row_mask:0xf bank_mask:0xf
    v_add_f32_dpp v27, v27, v27 quad_perm:[1,0,3,2] row_mask:0xf bank_mask:0xf
L_gx1n:
    v_add_f32_dpp v24, v24, v24 quad_perm:[2,3,0,1] row_mask:0xf bank_mask:0xf
    v_add_f32_dpp v25, v25, v25 quad_perm:[2,3,0,1] row_mask:0xf bank_mask:0xf
    v_add_f32_dpp v26, v26, v26 quad_perm:[2,3,0,1] row_mask:0xf bank_mask:0xf
    v_add_f32_dpp v27, v27, v27 quad_perm:[2,3,0,1] row_mask:0xf bank_mask:0xf
    v_add_f32_dpp v24, v24, v24 row_half_mirror row_mask:0xf bank_mask:0xf
    v_add_f32_dpp v25, v25, v25 row_half_mirror row_mask:0xf bank_mask:0xf
    v_add_f32_dpp v26, v26, v26 row_half_mirror row_mask:0xf bank_mask:0xf
    v_add_f32_dpp v27, v27, v27 row_half_mirror row_mask:0xf bank_mask:0xf
    v_cvt_pk_bf16_f32 v24, v24, v25
    v_cvt_pk_bf16_f32 v25, v26, v27
    v_perm_b32 v28, v24, v24, v136
    v_perm_b32 v29, v24, v24, v137
    v_perm_b32 v30, v24, v24, v138
    v_perm_b32 v31, v24, v24, v139
    v_perm_b32 v32, v24, v24, v140
    v_perm_b32 v33, v24, v24, v141
    v_perm_b32 v34, v24, v24, v142
    v_perm_b32 v35, v24, v24, v143
    v_perm_b32 v36, v25, v25, v136
    v_perm_b32 v37, v25, v25, v137
    v_perm_b32 v38, v25, v25, v138
    v_perm_b32 v39, v25, v25, v139
    v_perm_b32 v40, v25, v25, v140
    v_perm_b32 v41, v25, v25, v141
    v_perm_b32 v42, v25, v25, v142
    v_perm_b32 v43, v25, v25, v143
    v_mfma_f32_16x16x32_bf16 v[192:195], v[28:31], v[144:147], 0
    v_mfma_f32_16x16x32_bf16 v[196:199], v[28:31], v[160:163], 0
    v_mfma_f32_16x16x32_bf16 v[192:195], v[32:35], v[148:151], v[192:195]
    v_mfma_f32_16x16x32_bf16 v[196:199], v[32:35], v[164:167], v[196:199]
    v_mfma_f32_16x16x32_bf16 v[192:195], v[36:39], v[152:155], v[192:195]
    v_mfma_f32_16x16x32_bf16 v[196:199], v[36:39], v[168:171], v[196:199]
    v_mfma_f32_16x16x32_bf16 v[192:195], v[40:43], v[156:159], v[192:195]
    v_mfma_f32_16x16x32_bf16 v[196:199], v[40:43], v[172:175], v[196:199]
    s_cmp_lg_u32 s37, 3
    s_cbranch_scc1 L_no3
    v_mfma_f32_16x16x32_bf16 v[200:203], v[28:31], v[176:179], 0
    v_mfma_f32_16x16x32_bf16 v[200:203], v[32:35], v[180:183], v[200:203]
    v_mfma_f32_16x16x32_bf16 v[200:203], v[36:39], v[184:187], v[200:203]
    v_mfma_f32_16x16x32_bf16 v[200:203], v[40:43], v[188:191], v[200:203]
    s_nop 7
    v_permlane32_swap_b32 v200, v204
    v_permlane32_swap_b32 v201, v205
    v_permlane32_swap_b32 v202, v206
    v_permlane32_swap_b32 v203, v207
    v_add_f32_dpp v200, v204, v200 row_ror:8 row_mask:0xf bank_mask:0xf
    v_add_f32_dpp v201, v205, v201 row_ror:8 row_mask:0xf bank_mask:0xf
    v_add_f32_dpp v202, v206, v202 row_ror:8 row_mask:0xf bank_mask:0xf
    v_add_f32_dpp v203, v207, v203 row_ror:8 row_mask:0xf bank_mask:0xf
    v_bfi_b32 v200, v3, s64, v200
    v_bfi_b32 v201, v3, s65, v201
    v_bfi_b32 v202, v3, s66, v202
    v_bfi_b32 v203, v3, s67, v203
    v_add_u32 v21, 0x10000, v18
    s_mov_b64 exec, 0x00ff00ff
    global_store_dwordx4 v21, v[200:203], s[28:29] sc1
    s_mov_b64 exec, -1
L_no3:
    s_nop 7
    v_permlane32_swap_b32 v192, v196
    v_permlane32_swap_b32 v193, v197
    v_permlane32_swap_b32 v194, v198
    v_permlane32_swap_b32 v195, v199
    v_add_f32_dpp v192, v196, v192 row_ror:8 row_mask:0xf bank_mask:0xf
    v_add_f32_dpp v193, v197, v193 row_ror:8 row_mask:0xf bank_mask:0xf
    v_add_f32_dpp v194, v198, v194 row_ror:8 row_mask:0xf bank_mask:0xf
    v_add_f32_dpp v195, v199, v195 row_ror:8 row_mask:0xf bank_mask:0xf
    v_bfi_b32 v192, v3, s64, v192
    v_bfi_b32 v193, v3, s65, v193
    v_bfi_b32 v194, v3, s66, v194
    v_bfi_b32 v195, v3, s67, v195
    s_mov_b32 exec_lo, 0x00ff00ff
    s_mov_b32 exec_hi, 0x00ff00ff
    global_store_dwordx4 v18, v[192:195], s[28:29] sc1
    s_mov_b64 exec, -1
    s_cmp_ge_u32 s2, 36
    s_cbranch_scc1 L_fin
    s_nop 0
    global_load_dwordx4 v[64:67], v55, s[28:29] offset:0 sc1
    global_load_dwordx4 v[68:71], v55, s[28:29] offset:1024 sc1
    global_load_dwordx4 v[72:75], v55, s[28:29] offset:2048 sc1
    global_load_dwordx4 v[76:79], v55, s[28:29] offset:3072 sc1
L_px2:
    global_load_dwordx4 v[80:83], v55, s[28:29] offset:0 sc1
    global_load_dwordx4 v[84:87], v55, s[28:29] offset:1024 sc1
    global_load_dwordx4 v[88:91], v55, s[28:29] offset:2048 sc1
    global_load_dwordx4 v[92:95], v55, s[28:29] offset:3072 sc1
    s_sub_u32 s52, s52, 1
    s_cbranch_scc1 L_gx2
    s_waitcnt vmcnt(7)
    v_xor_b32 v64, s64, v64
    v_xor_b32 v65, s65, v65
    v_xor_b32 v66, s66, v66
    v_xor_b32 v67, s67, v67
    v_or3_b32 v40, v64, v65, v66
    v_or_b32 v40, v40, v67
    s_waitcnt vmcnt(6)
    v_xor_b32 v68, s64, v68
    v_xor_b32 v69, s65, v69
    v_xor_b32 v70, s66, v70
    v_xor_b32 v71, s67, v71
    v_or3_b32 v40, v40, v68, v69
    v_or3_b32 v40, v40, v70, v71
    s_waitcnt vmcnt(5)
    v_xor_b32 v72, s64, v72
    v_xor_b32 v73, s65, v73
    v_xor_b32 v74, s66, v74
    v_xor_b32 v75, s67, v75
    v_or3_b32 v40, v40, v72, v73
    v_or3_b32 v40, v40, v74, v75
    s_waitcnt vmcnt(4)
    v_xor_b32 v76, s64, v76
    v_xor_b32 v77, s65, v77
    v_xor_b32 v78, s66, v78
    v_xor_b32 v79, s67, v79
    v_or3_b32 v40, v40, v76, v77
    v_or3_b32 v40, v40, v78, v79
    v_and_b32 v40, 0xff, v40
    v_cmp_ne_u32 vcc, 0, v40
    s_cbranch_vccz L_gx2
    global_load_dwordx4 v[64:67], v55, s[28:29] offset:0 sc1
    global_load_dwordx4 v[68:71], v55, s[28:29] offset:1024 sc1
    global_load_dwordx4 v[72:75], v55, s[28:29] offset:2048 sc1
    global_load_dwordx4 v[76:79], v55, s[28:29] offset:3072 sc1
    s_waitcnt vmcnt(7)
    v_xor_b32 v80, s64, v80
    v_xor_b32 v81, s65, v81
    v_xor_b32 v82, s66, v82
    v_xor_b32 v83, s67, v83
    v_or3_b32 v40, v80, v81, v82
    v_or_b32 v40, v40, v83
    s_waitcnt vmcnt(6)
    v_xor_b32 v84, s64, v84
    v_xor_b32 v85, s65, v85
    v_xor_b32 v86, s66, v86
    v_xor_b32 v87, s67, v87
    v_or3_b32 v40, v40, v84, v85
    v_or3_b32 v40, v40, v86, v87
    s_waitcnt vmcnt(5)
    v_xor_b32 v88, s64, v88
    v_xor_b32 v89, s65, v89
    v_xor_b32 v90, s66, v90
    v_xor_b32 v91, s67, v91
    v_or3_b32 v40, v40, v88, v89
    v_or3_b32 v40, v40, v90, v91
    s_waitcnt vmcnt(4)
    v_xor_b32 v92, s64, v92
    v_xor_b32 v93, s65, v93
    v_xor_b32 v94, s66, v94
    v_xor_b32 v95, s67, v95
    v_or3_b32 v40, v40, v92, v93
    v_or3_b32 v40, v40, v94, v95
    v_and_b32 v40, 0xff, v40
    v_cmp_ne_u32 vcc, 0, v40
    s_cbranch_vccnz L_px2
    v_pk_add_f32 v[24:25], v[80:81], v[84:85]
    v_pk_add_f32 v[26:27], v[82:83], v[86:87]
    v_pk_add_f32 v[32:33], v[88:89], v[92:93]
    v_pk_add_f32 v[34:35], v[90:91], v[94:95]
    s_branch L_gx3
L_gx2:
    s_waitcnt vmcnt(4)
    v_pk_add_f32 v[24:25], v[64:65], v[68:69]
    v_pk_add_f32 v[26:27], v[66:67], v[70:71]
    v_pk_add_f32 v[32:33], v[72:73], v[76:77]
    v_pk_add_f32 v[34:35], v[74:75], v[78:79]
L_gx3:
    v_pk_add_f32 v[24:25], v[24:25], v[32:33]
    v_pk_add_f32 v[26:27], v[26:27], v[34:35]
    s_nop 0
    v_permlane16_swap_b32 v24, v25
    v_permlane16_swap_b32 v26, v27
    v_add_f32 v24, v24, v25
    v_add_f32 v26, v26, v27
    s_nop 1
    v_permlane32_swap_b32 v24, v26
    v_add_f32 v24, v24, v26
    s_nop 1
    v_add_f32_dpp v24, v24, v24 row_ror:8 row_mask:0xf bank_mask:0xf
    ds_write_b32 v60, v24 offset:1024
    v_lshlrev_b32 v21, 2, v0
    s_cmp_lg_u32 s37, 1
    s_waitcnt lgkmcnt(0)
    s_barrier
    s_cbranch_scc1 L_fin
    ds_read2st64_b32 v[24:25], v21 offset0:4 offset1:5
    ds_read2st64_b32 v[26:27], v21 offset0:6 offset1:7
    s_waitcnt lgkmcnt(0)
    v_pk_add_f32 v[24:25], v[24:25], v[26:27]
    v_add_f32 v24, v24, v25
    v_cvt_pk_bf16_f32 v24, v24, v24
    v_lshlrev_b32 v24, 16, v24
    v_mul_f32 v24, v24, v54
    v_cvt_pk_bf16_f32 v24, v24, v24
    v_lshlrev_b32 v24, 16, v24
    v_add_f32 v24, v24, v53
    v_cvt_pk_bf16_f32 v24, v24, v24
    s_mov_b32 exec_lo, 0x00ff00ff
    s_mov_b32 exec_hi, 0x00ff00ff
    global_store_short v52, v24, s[24:25]
L_fin:
L_end:
    s_endpgm
L_stream:
    v_lshlrev_b32 v2, 4, v0
    s_mov_b32 s44, s8
    s_mov_b32 s45, s9
    s_mov_b32 s46, 0x4000000
    s_mov_b32 s47, 0x20000
    s_mov_b32 s39, 0xffff0000
    v_and_b32 v6, 1, v0
    v_cmp_eq_u32 vcc, 1, v6
    v_mov_b32 v6, 0x0c0c0100
    v_mov_b32 v7, 0x01000c0c
    v_cndmask_b32 v15, v6, v7, vcc
    v_mov_b32 v6, 0x0c0c0302
    v_mov_b32 v7, 0x03020c0c
    v_cndmask_b32 v19, v6, v7, vcc
    v_bfe_u32 v6, v0, 1, 2
    v_mov_b32 v7, 0x0c0c0c0c
    v_cmp_eq_u32 vcc, 0, v6
    s_nop 1
    v_cndmask_b32 v12, v7, v15, vcc
    v_cndmask_b32 v16, v7, v19, vcc
    v_cmp_eq_u32 vcc, 1, v6
    s_nop 1
    v_cndmask_b32 v13, v7, v15, vcc
    v_cndmask_b32 v17, v7, v19, vcc
    v_cmp_eq_u32 vcc, 2, v6
    s_nop 1
    v_cndmask_b32 v14, v7, v15, vcc
    v_cndmask_b32 v18, v7, v19, vcc
    v_cmp_eq_u32 vcc, 3, v6
    s_nop 1
    v_cndmask_b32 v15, v7, v15, vcc
    v_cndmask_b32 v19, v7, v19, vcc
    v_bfe_u32 v6, v0, 3, 1
    v_and_b32 v7, 0x33, v0
    v_lshrrev_b32 v3, 4, v7
    v_and_b32 v7, 3, v7
    v_lshlrev_b32 v7, 4, v7
    v_lshl_add_u32 v7, v3, 6, v7
    v_lshl_add_u32 v7, v6, 8, v7
    v_mov_b32 v3, 0xff800000
    v_mov_b32 v4, 0
    s_mov_b32 s50, 1035273459
    s_mov_b32 s51, 1069066811
    s_mov_b32 s52, 3000000
    s_waitcnt vmcnt(7)
    s_add_u32 m0, m0, 0x1000
    s_add_u32 s54, s54, 0x4000
    s_and_b32 s54, s54, 0x3ffff
    s_add_u32 s49, s48, s54
    buffer_load_dwordx4 v1, s[40:43], s49 offen offset:0 nt lds
    s_waitcnt vmcnt(7)
    buffer_load_dwordx4 v1, s[40:43], s49 offen offset:1024 nt lds
    s_waitcnt vmcnt(7)
    buffer_load_dwordx4 v1, s[40:43], s49 offen offset:2048 nt lds
    s_waitcnt vmcnt(7)
    buffer_load_dwordx4 v1, s[40:43], s49 offen offset:3072 nt lds
    s_waitcnt vmcnt(7)
    s_add_u32 m0, m0, 0x1000
    s_add_u32 s54, s54, 0x4000
    s_and_b32 s54, s54, 0x3ffff
    s_add_u32 s49, s48, s54
    buffer_load_dwordx4 v1, s[40:43], s49 offen offset:0 nt lds
    s_waitcnt vmcnt(7)
    buffer_load_dwordx4 v1, s[40:43], s49 offen offset:1024 nt lds
    s_waitcnt vmcnt(7)
    buffer_load_dwordx4 v1, s[40:43], s49 offen offset:2048 nt lds
    s_waitcnt vmcnt(7)
    buffer_load_dwordx4 v1, s[40:43], s49 offen offset:3072 nt lds
    s_waitcnt vmcnt(4)
    s_add_u32 m0, m0, 0x1000
    s_add_u32 s54, s54, 0x4000
    s_and_b32 s54, s54, 0x3ffff
    s_add_u32 s49, s48, s54
    buffer_load_dwordx4 v1, s[40:43], s49 offen offset:0 nt lds
    s_waitcnt vmcnt(4)
    buffer_load_dwordx4 v1, s[40:43], s49 offen offset:1024 nt lds
    s_waitcnt vmcnt(4)
    buffer_load_dwordx4 v1, s[40:43], s49 offen offset:2048 nt lds
    s_waitcnt vmcnt(4)
    buffer_load_dwordx4 v1, s[40:43], s49 offen offset:3072 nt lds
    s_waitcnt vmcnt(4)
    s_add_u32 s54, s54, 0x4000
    s_and_b32 s54, s54, 0x3ffff
    s_add_u32 s49, s48, s54
    buffer_load_dwordx4 v[72:75], v1, s[40:43], s49 offen offset:0 nt
    s_waitcnt vmcnt(4)
    buffer_load_dwordx4 v[76:79], v1, s[40:43], s49 offen offset:1024 nt
    s_waitcnt vmcnt(4)
    buffer_load_dwordx4 v[80:83], v1, s[40:43], s49 offen offset:2048 nt
    s_waitcnt vmcnt(4)
    buffer_load_dwordx4 v[84:87], v1, s[40:43], s49 offen offset:3072 nt
    s_waitcnt vmcnt(4)
    s_add_u32 s54, s54, 0x4000
    s_and_b32 s54, s54, 0x3ffff
    s_add_u32 s49, s48, s54
    buffer_load_dwordx4 v[88:91], v1, s[40:43], s49 offen offset:0 nt
    s_waitcnt vmcnt(4)
    buffer_load_dwordx4 v[92:95], v1, s[40:43], s49 offen offset:1024 nt
    s_waitcnt vmcnt(4)
    buffer_load_dwordx4 v[96:99], v1, s[40:43], s49 offen offset:2048 nt
    s_waitcnt vmcnt(4)
    buffer_load_dwordx4 v[100:103], v1, s[40:43], s49 offen offset:3072 nt
    s_waitcnt vmcnt(4)
    s_add_u32 s54, s54, 0x4000
    s_and_b32 s54, s54, 0x3ffff
    s_add_u32 s49, s48, s54
    buffer_load_dwordx4 v[104:107], v1, s[40:43], s49 offen offset:0 nt
    s_waitcnt vmcnt(4)
    buffer_load_dwordx4 v[108:111], v1, s[40:43], s49 offen offset:1024 nt
    s_waitcnt vmcnt(4)
    buffer_load_dwordx4 v[112:115], v1, s[40:43], s49 offen offset:2048 nt
    s_waitcnt vmcnt(4)
    buffer_load_dwordx4 v[116:119], v1, s[40:43], s49 offen offset:3072 nt
    s_waitcnt vmcnt(4)
    s_add_u32 s54, s54, 0x4000
    s_and_b32 s54, s54, 0x3ffff
    s_add_u32 s49, s48, s54
    buffer_load_dwordx4 v[120:123], v1, s[40:43], s49 offen offset:0 nt
    s_waitcnt vmcnt(4)
    buffer_load_dwordx4 v[124:127], v1, s[40:43], s49 offen offset:1024 nt
    s_waitcnt vmcnt(4)
    buffer_load_dwordx4 v[128:131], v1, s[40:43], s49 offen offset:2048 nt
    s_waitcnt vmcnt(4)
    buffer_load_dwordx4 v[132:135], v1, s[40:43], s49 offen offset:3072 nt
    s_waitcnt vmcnt(4)
    s_add_u32 s54, s54, 0x4000
    s_and_b32 s54, s54, 0x3ffff
    s_add_u32 s49, s48, s54
    buffer_load_dwordx4 v[136:139], v1, s[40:43], s49 offen offset:0 nt
    s_waitcnt vmcnt(4)
    buffer_load_dwordx4 v[140:143], v1, s[40:43], s49 offen offset:1024 nt
    s_waitcnt vmcnt(4)
    buffer_load_dwordx4 v[144:147], v1, s[40:43], s49 offen offset:2048 nt
    s_waitcnt vmcnt(4)
    buffer_load_dwordx4 v[148:151], v1, s[40:43], s49 offen offset:3072 nt
    s_waitcnt vmcnt(4)
    s_add_u32 s54, s54, 0x4000
    s_and_b32 s54, s54, 0x3ffff
    s_add_u32 s49, s48, s54
    buffer_load_dwordx4 v[152:155], v1, s[40:43], s49 offen offset:0 nt
    s_waitcnt vmcnt(4)
    buffer_load_dwordx4 v[156:159], v1, s[40:43], s49 offen offset:1024 nt
    s_waitcnt vmcnt(4)
    buffer_load_dwordx4 v[160:163], v1, s[40:43], s49 offen offset:2048 nt
    s_waitcnt vmcnt(4)
    buffer_load_dwordx4 v[164:167], v1, s[40:43], s49 offen offset:3072 nt
    s_waitcnt vmcnt(4)
    s_add_u32 s54, s54, 0x4000
    s_and_b32 s54, s54, 0x3ffff
    s_add_u32 s49, s48, s54
    buffer_load_dwordx4 v[168:171], v1, s[40:43], s49 offen offset:0 nt
    v_mov_b32 v6, 1
    s_mov_b64 exec, 1
    ds_max_i32 v23, v6 offset:772
    s_mov_b64 exec, -1
    s_waitcnt vmcnt(4)
    buffer_load_dwordx4 v[172:175], v1, s[40:43], s49 offen offset:1024 nt
    s_waitcnt vmcnt(4)
    buffer_load_dwordx4 v[176:179], v1, s[40:43], s49 offen offset:2048 nt
    s_waitcnt vmcnt(4)
    buffer_load_dwordx4 v[180:183], v1, s[40:43], s49 offen offset:3072 nt
    s_waitcnt vmcnt(4)
    s_add_u32 s54, s54, 0x4000
    s_and_b32 s54, s54, 0x3ffff
    s_add_u32 s49, s48, s54
    buffer_load_dwordx4 v[184:187], v1, s[40:43], s49 offen offset:0 nt
    s_waitcnt vmcnt(4)
    buffer_load_dwordx4 v[188:191], v1, s[40:43], s49 offen offset:1024 nt
    s_waitcnt vmcnt(4)
    buffer_load_dwordx4 v[192:195], v1, s[40:43], s49 offen offset:2048 nt
    s_waitcnt vmcnt(4)
    buffer_load_dwordx4 v[196:199], v1, s[40:43], s49 offen offset:3072 nt
    s_waitcnt vmcnt(4)
    s_add_u32 s54, s54, 0x4000
    s_and_b32 s54, s54, 0x3ffff
    s_add_u32 s49, s48, s54
    buffer_load_dwordx4 v[200:203], v1, s[40:43], s49 offen offset:0 nt
    s_waitcnt vmcnt(4)
    buffer_load_dwordx4 v[204:207], v1, s[40:43], s49 offen offset:1024 nt
    s_waitcnt vmcnt(4)
    buffer_load_dwordx4 v[208:211], v1, s[40:43], s49 offen offset:2048 nt
    s_waitcnt vmcnt(4)
    buffer_load_dwordx4 v[212:215], v1, s[40:43], s49 offen offset:3072 nt
    s_waitcnt vmcnt(4)
    s_add_u32 s54, s54, 0x4000
    s_and_b32 s54, s54, 0x3ffff
    s_add_u32 s49, s48, s54
    buffer_load_dwordx4 v[216:219], v1, s[40:43], s49 offen offset:0 nt
    s_waitcnt vmcnt(4)
    buffer_load_dwordx4 v[220:223], v1, s[40:43], s49 offen offset:1024 nt
    s_waitcnt vmcnt(4)
    buffer_load_dwordx4 v[224:227], v1, s[40:43], s49 offen offset:2048 nt
    s_waitcnt vmcnt(4)
    buffer_load_dwordx4 v[228:231], v1, s[40:43], s49 offen offset:3072 nt
    s_waitcnt vmcnt(4)
    s_add_u32 s54, s54, 0x4000
    s_and_b32 s54, s54, 0x3ffff
    s_add_u32 s49, s48, s54
    buffer_load_dwordx4 v[232:235], v1, s[40:43], s49 offen offset:0 nt
    s_waitcnt vmcnt(4)
    buffer_load_dwordx4 v[236:239], v1, s[40:43], s49 offen offset:1024 nt
    s_waitcnt vmcnt(4)
    buffer_load_dwordx4 v[240:243], v1, s[40:43], s49 offen offset:2048 nt
    s_waitcnt vmcnt(4)
    buffer_load_dwordx4 v[244:247], v1, s[40:43], s49 offen offset:3072 nt
L_twq:
    ds_read_b32 v5, v23 offset:768
    ds_read_b128 v[8:11], v7 offset:0
    s_sub_u32 s52, s52, 1
    s_cbranch_scc1 L_tgq
    s_waitcnt lgkmcnt(0)
    v_cmp_eq_u32 vcc, -1, v5
    s_cbranch_vccz L_tgq
    s_sleep 1
    s_branch L_twq
L_tgq:
    s_waitcnt lgkmcnt(0)
    v_add_u32 v7, s53, v2
    v_mfma_f32_16x16x32_bf16 v[24:27], v[72:75], v[8:11], 0
    v_mfma_f32_16x16x32_bf16 v[28:31], v[76:79], v[8:11], 0
    v_mfma_f32_16x16x32_bf16 v[32:35], v[80:83], v[8:11], 0
    v_mfma_f32_16x16x32_bf16 v[36:39], v[84:87], v[8:11], 0
    s_add_u32 s54, s54, 0x4000
    s_and_b32 s54, s54, 0x3ffff
    s_add_u32 s49, s48, s54
    buffer_load_dwordx4 v[248:251], v2, s[44:47], s49 offen offset:0 nt
    s_nop 0
    v_add_f32_dpp v24, v25, v24 quad_perm:[1,1,1,1] row_mask:0xf bank_mask:0xf
    v_add_f32_dpp v26, v27, v26 quad_perm:[3,3,3,3] row_mask:0xf bank_mask:0xf
    v_add_f32_dpp v28, v29, v28 quad_perm:[1,1,1,1] row_mask:0xf bank_mask:0xf
    v_add_f32_dpp v30, v31, v30 quad_perm:[3,3,3,3] row_mask:0xf bank_mask:0xf
    v_add_f32_dpp v32, v33, v32 quad_perm:[1,1,1,1] row_mask:0xf bank_mask:0xf
    v_add_f32_dpp v34, v35, v34 quad_perm:[3,3,3,3] row_mask:0xf bank_mask:0xf
    v_add_f32_dpp v36, v37, v36 quad_perm:[1,1,1,1] row_mask:0xf bank_mask:0xf
    v_add_f32_dpp v38, v39, v38 quad_perm:[3,3,3,3] row_mask:0xf bank_mask:0xf
    v_add_f32_dpp v24, v26, v24 quad_perm:[2,2,2,2] row_mask:0xf bank_mask:0xf
    v_add_f32_dpp v28, v30, v28 quad_perm:[2,2,2,2] row_mask:0xf bank_mask:0xf
    v_add_f32_dpp v32, v34, v32 quad_perm:[2,2,2,2] row_mask:0xf bank_mask:0xf
    v_add_f32_dpp v36, v38, v36 quad_perm:[2,2,2,2] row_mask:0xf bank_mask:0xf
    v_cvt_pk_bf16_f32 v25, v24, v28
    v_cvt_pk_bf16_f32 v33, v32, v36
    v_lshlrev_b32 v24, 16, v25
    v_and_b32 v28, s39, v25
    v_mul_f32 v24, s50, v24
    v_mul_f32 v28, s50, v28
    v_max3_f32 v3, v3, v24, v28
    v_cvt_pk_bf16_f32 v50, v24, v28
    v_lshlrev_b32 v32, 16, v33
    v_and_b32 v36, s39, v33
    v_mul_f32 v32, s50, v32
    v_mul_f32 v36, s50, v36
    v_max3_f32 v3, v3, v32, v36
    v_cvt_pk_bf16_f32 v51, v32, v36
    v_mfma_f32_16x16x32_bf16 v[24:27], v[88:91], v[8:11], 0
    v_mfma_f32_16x16x32_bf16 v[28:31], v[92:95], v[8:11], 0
    v_mfma_f32_16x16x32_bf16 v[32:35], v[96:99], v[8:11], 0
    v_mfma_f32_16x16x32_bf16 v[36:39], v[100:103], v[8:11], 0
    buffer_load_dwordx4 v[252:255], v2, s[44:47], s49 offen offset:1024 nt
    s_nop 3
    v_add_f32_dpp v24, v25, v24 quad_perm:[1,1,1,1] row_mask:0xf bank_mask:0xf
    v_add_f32_dpp v26, v27, v26 quad_perm:[3,3,3,3] row_mask:0xf bank_mask:0xf
    v_add_f32_dpp v28, v29, v28 quad_perm:[1,1,1,1] row_mask:0xf bank_mask:0xf
    v_add_f32_dpp v30, v31, v30 quad_perm:[3,3,3,3] row_mask:0xf bank_mask:0xf
    v_add_f32_dpp v32, v33, v32 quad_perm:[1,1,1,1] row_mask:0xf bank_mask:0xf
    v_add_f32_dpp v34, v35, v34 quad_perm:[3,3,3,3] row_mask:0xf bank_mask:0xf
    v_add_f32_dpp v36, v37, v36 quad_perm:[1,1,1,1] row_mask:0xf bank_mask:0xf
    v_add_f32_dpp v38, v39, v38 quad_perm:[3,3,3,3] row_mask:0xf bank_mask:0xf
    v_add_f32_dpp v24, v26, v24 quad_perm:[2,2,2,2] row_mask:0xf bank_mask:0xf
    v_add_f32_dpp v28, v30, v28 quad_perm:[2,2,2,2] row_mask:0xf bank_mask:0xf
    v_add_f32_dpp v32, v34, v32 quad_perm:[2,2,2,2] row_mask:0xf bank_mask:0xf
    v_add_f32_dpp v36, v38, v36 quad_perm:[2,2,2,2] row_mask:0xf bank_mask:0xf
    v_cvt_pk_bf16_f32 v25, v24, v28
    v_cvt_pk_bf16_f32 v33, v32, v36
    v_lshlrev_b32 v24, 16, v25
    v_and_b32 v28, s39, v25
    v_mul_f32 v24, s50, v24
    v_mul_f32 v28, s50, v28
    v_max3_f32 v3, v3, v24, v28
    v_cvt_pk_bf16_f32 v52, v24, v28
    v_lshlrev_b32 v32, 16, v33
    v_and_b32 v36, s39, v33
    v_mul_f32 v32, s50, v32
    v_mul_f32 v36, s50, v36
    v_max3_f32 v3, v3, v32, v36
    v_cvt_pk_bf16_f32 v53, v32, v36
    v_mfma_f32_16x16x32_bf16 v[24:27], v[104:107], v[8:11], 0
    v_mfma_f32_16x16x32_bf16 v[28:31], v[108:111], v[8:11], 0
    v_mfma_f32_16x16x32_bf16 v[32:35], v[112:115], v[8:11], 0
    v_mfma_f32_16x16x32_bf16 v[36:39], v[116:119], v[8:11], 0
    buffer_load_dwordx4 v[72:75], v2, s[44:47], s49 offen offset:2048 nt
    s_nop 3
    v_add_f32_dpp v24, v25, v24 quad_perm:[1,1,1,1] row_mask:0xf bank_mask:0xf
    v_add_f32_dpp v26, v27, v26 quad_perm:[3,3,3,3] row_mask:0xf bank_mask:0xf
    v_add_f32_dpp v28, v29, v28 quad_perm:[1,1,1,1] row_mask:0xf bank_mask:0xf
    v_add_f32_dpp v30, v31, v30 quad_perm:[3,3,3,3] row_mask:0xf bank_mask:0xf
    v_add_f32_dpp v32, v33, v32 quad_perm:[1,1,1,1] row_mask:0xf bank_mask:0xf
    v_add_f32_dpp v34, v35, v34 quad_perm:[3,3,3,3] row_mask:0xf bank_mask:0xf
    v_add_f32_dpp v36, v37, v36 quad_perm:[1,1,1,1] row_mask:0xf bank_mask:0xf
    v_add_f32_dpp v38, v39, v38 quad_perm:[3,3,3,3] row_mask:0xf bank_mask:0xf
    v_add_f32_dpp v24, v26, v24 quad_perm:[2,2,2,2] row_mask:0xf bank_mask:0xf
    v_add_f32_dpp v28, v30, v28 quad_perm:[2,2,2,2] row_mask:0xf bank_mask:0xf
    v_add_f32_dpp v32, v34, v32 quad_perm:[2,2,2,2] row_mask:0xf bank_mask:0xf
    v_add_f32_dpp v36, v38, v36 quad_perm:[2,2,2,2] row_mask:0xf bank_mask:0xf
    v_cvt_pk_bf16_f32 v25, v24, v28
    v_cvt_pk_bf16_f32 v33, v32, v36
    v_lshlrev_b32 v24, 16, v25
    v_and_b32 v28, s39, v25
    v_mul_f32 v24, s50, v24
    v_mul_f32 v28, s50, v28
    v_max3_f32 v3, v3, v24, v28
    v_cvt_pk_bf16_f32 v54, v24, v28
    v_lshlrev_b32 v32, 16, v33
    v_and_b32 v36, s39, v33
    v_mul_f32 v32, s50, v32
    v_mul_f32 v36, s50, v36
    v_max3_f32 v3, v3, v32, v36
    v_cvt_pk_bf16_f32 v55, v32, v36
    v_mfma_f32_16x16x32_bf16 v[24:27], v[120:123], v[8:11], 0
    v_mfma_f32_16x16x32_bf16 v[28:31], v[124:127], v[8:11], 0
    v_mfma_f32_16x16x32_bf16 v[32:35], v[128:131], v[8:11], 0
    v_mfma_f32_16x16x32_bf16 v[36:39], v[132:135], v[8:11], 0
    buffer_load_dwordx4 v[76:79], v2, s[44:47], s49 offen offset:3072 nt
    s_nop 3
    v_add_f32_dpp v24, v25, v24 quad_perm:[1,1,1,1] row_mask:0xf bank_mask:0xf
    v_add_f32_dpp v26, v27, v26 quad_perm:[3,3,3,3] row_mask:0xf bank_mask:0xf
    v_add_f32_dpp v28, v29, v28 quad_perm:[1,1,1,1] row_mask:0xf bank_mask:0xf
    v_add_f32_dpp v30, v31, v30 quad_perm:[3,3,3,3] row_mask:0xf bank_mask:0xf
    v_add_f32_dpp v32, v33, v32 quad_perm:[1,1,1,1] row_mask:0xf bank_mask:0xf
    v_add_f32_dpp v34, v35, v34 quad_perm:[3,3,3,3] row_mask:0xf bank_mask:0xf
    v_add_f32_dpp v36, v37, v36 quad_perm:[1,1,1,1] row_mask:0xf bank_mask:0xf
    v_add_f32_dpp v38, v39, v38 quad_perm:[3,3,3,3] row_mask:0xf bank_mask:0xf
    v_add_f32_dpp v24, v26, v24 quad_perm:[2,2,2,2] row_mask:0xf bank_mask:0xf
    v_add_f32_dpp v28, v30, v28 quad_perm:[2,2,2,2] row_mask:0xf bank_mask:0xf
    v_add_f32_dpp v32, v34, v32 quad_perm:[2,2,2,2] row_mask:0xf bank_mask:0xf
    v_add_f32_dpp v36, v38, v36 quad_perm:[2,2,2,2] row_mask:0xf bank_mask:0xf
    v_cvt_pk_bf16_f32 v25, v24, v28
    v_cvt_pk_bf16_f32 v33, v32, v36
    v_lshlrev_b32 v24, 16, v25
    v_and_b32 v28, s39, v25
    v_mul_f32 v24, s50, v24
    v_mul_f32 v28, s50, v28
    v_max3_f32 v3, v3, v24, v28
    v_cvt_pk_bf16_f32 v56, v24, v28
    v_lshlrev_b32 v32, 16, v33
    v_and_b32 v36, s39, v33
    v_mul_f32 v32, s50, v32
    v_mul_f32 v36, s50, v36
    v_max3_f32 v3, v3, v32, v36
    v_cvt_pk_bf16_f32 v57, v32, v36
    v_mfma_f32_16x16x32_bf16 v[24:27], v[136:139], v[8:11], 0
    v_mfma_f32_16x16x32_bf16 v[28:31], v[140:143], v[8:11], 0
    v_mfma_f32_16x16x32_bf16 v[32:35], v[144:147], v[8:11], 0
    v_mfma_f32_16x16x32_bf16 v[36:39], v[148:151], v[8:11], 0
    s_add_u32 s54, s54, 0x4000
    s_and_b32 s54, s54, 0x3ffff
    s_add_u32 s49, s48, s54
    buffer_load_dwordx4 v[80:83], v2, s[44:47], s49 offen offset:0 nt
    s_nop 0
    v_add_f32_dpp v24, v25, v24 quad_perm:[1,1,1,1] row_mask:0xf bank_mask:0xf
    v_add_f32_dpp v26, v27, v26 quad_perm:[3,3,3,3] row_mask:0xf bank_mask:0xf
    v_add_f32_dpp v28, v29, v28 quad_perm:[1,1,1,1] row_mask:0xf bank_mask:0xf
    v_add_f32_dpp v30, v31, v30 quad_perm:[3,3,3,3] row_mask:0xf bank_mask:0xf
    v_add_f32_dpp v32, v33, v32 quad_perm:[1,1,1,1] row_mask:0xf bank_mask:0xf
    v_add_f32_dpp v34, v35, v34 quad_perm:[3,3,3,3] row_mask:0xf bank_mask:0xf
    v_add_f32_dpp v36, v37, v36 quad_perm:[1,1,1,1] row_mask:0xf bank_mask:0xf
    v_add_f32_dpp v38, v39, v38 quad_perm:[3,3,3,3] row_mask:0xf bank_mask:0xf
    v_add_f32_dpp v24, v26, v24 quad_perm:[2,2,2,2] row_mask:0xf bank_mask:0xf
    v_add_f32_dpp v28, v30, v28 quad_perm:[2,2,2,2] row_mask:0xf bank_mask:0xf
    v_add_f32_dpp v32, v34, v32 quad_perm:[2,2,2,2] row_mask:0xf bank_mask:0xf
    v_add_f32_dpp v36, v38, v36 quad_perm:[2,2,2,2] row_mask:0xf bank_mask:0xf
    v_cvt_pk_bf16_f32 v25, v24, v28
    v_cvt_pk_bf16_f32 v33, v32, v36
    v_lshlrev_b32 v24, 16, v25
    v_and_b32 v28, s39, v25
    v_mul_f32 v24, s50, v24
    v_mul_f32 v28, s50, v28
    v_max3_f32 v3, v3, v24, v28
    v_cvt_pk_bf16_f32 v58, v24, v28
    v_lshlrev_b32 v32, 16, v33
    v_and_b32 v36, s39, v33
    v_mul_f32 v32, s50, v32
    v_mul_f32 v36, s50, v36
    v_max3_f32 v3, v3, v32, v36
    v_cvt_pk_bf16_f32 v59, v32, v36
    v_mfma_f32_16x16x32_bf16 v[24:27], v[152:155], v[8:11], 0
    v_mfma_f32_16x16x32_bf16 v[28:31], v[156:159], v[8:11], 0
    v_mfma_f32_16x16x32_bf16 v[32:35], v[160:163], v[8:11], 0
    v_mfma_f32_16x16x32_bf16 v[36:39], v[164:167], v[8:11], 0
    s_waitcnt vmcnt(9)
    buffer_load_dwordx4 v[84:87], v2, s[44:47], s49 offen offset:1024 nt
    s_nop 2
    v_add_f32_dpp v24, v25, v24 quad_perm:[1,1,1,1] row_mask:0xf bank_mask:0xf
    v_add_f32_dpp v26, v27, v26 quad_perm:[3,3,3,3] row_mask:0xf bank_mask:0xf
    v_add_f32_dpp v28, v29, v28 quad_perm:[1,1,1,1] row_mask:0xf bank_mask:0xf
    v_add_f32_dpp v30, v31, v30 quad_perm:[3,3,3,3] row_mask:0xf bank_mask:0xf
    v_add_f32_dpp v32, v33, v32 quad_perm:[1,1,1,1] row_mask:0xf bank_mask:0xf
    v_add_f32_dpp v34, v35, v34 quad_perm:[3,3,3,3] row_mask:0xf bank_mask:0xf
    v_add_f32_dpp v36, v37, v36 quad_perm:[1,1,1,1] row_mask:0xf bank_mask:0xf
    v_add_f32_dpp v38, v39, v38 quad_perm:[3,3,3,3] row_mask:0xf bank_mask:0xf
    v_add_f32_dpp v24, v26, v24 quad_perm:[2,2,2,2] row_mask:0xf bank_mask:0xf
    v_add_f32_dpp v28, v30, v28 quad_perm:[2,2,2,2] row_mask:0xf bank_mask:0xf
    v_add_f32_dpp v32, v34, v32 quad_perm:[2,2,2,2] row_mask:0xf bank_mask:0xf
    v_add_f32_dpp v36, v38, v36 quad_perm:[2,2,2,2] row_mask:0xf bank_mask:0xf
    v_cvt_pk_bf16_f32 v25, v24, v28
    v_cvt_pk_bf16_f32 v33, v32, v36
    v_lshlrev_b32 v24, 16, v25
    v_and_b32 v28, s39, v25
    v_mul_f32 v24, s50, v24
    v_mul_f32 v28, s50, v28
    v_max3_f32 v3, v3, v24, v28
    v_cvt_pk_bf16_f32 v60, v24, v28
    v_lshlrev_b32 v32, 16, v33
    v_and_b32 v36, s39, v33
    v_mul_f32 v32, s50, v32
    v_mul_f32 v36, s50, v36
    v_max3_f32 v3, v3, v32, v36
    v_cvt_pk_bf16_f32 v61, v32, v36
    v_mfma_f32_16x16x32_bf16 v[24:27], v[168:171], v[8:11], 0
    v_mfma_f32_16x16x32_bf16 v[28:31], v[172:175], v[8:11], 0
    v_mfma_f32_16x16x32_bf16 v[32:35], v[176:179], v[8:11], 0
    v_mfma_f32_16x16x32_bf16 v[36:39], v[180:183], v[8:11], 0
    s_waitcnt vmcnt(9)
    buffer_load_dwordx4 v[88:91], v2, s[44:47], s49 offen offset:2048 nt
    s_nop 2
    v_add_f32_dpp v24, v25, v24 quad_perm:[1,1,1,1] row_mask:0xf bank_mask:0xf
    v_add_f32_dpp v26, v27, v26 quad_perm:[3,3,3,3] row_mask:0xf bank_mask:0xf
    v_add_f32_dpp v28, v29, v28 quad_perm:[1,1,1,1] row_mask:0xf bank_mask:0xf
    v_add_f32_dpp v30, v31, v30 quad_perm:[3,3,3,3] row_mask:0xf bank_mask:0xf
    v_add_f32_dpp v32, v33, v32 quad_perm:[1,1,1,1] row_mask:0xf bank_mask:0xf
    v_add_f32_dpp v34, v35, v34 quad_perm:[3,3,3,3] row_mask:0xf bank_mask:0xf
    v_add_f32_dpp v36, v37, v36 quad_perm:[1,1,1,1] row_mask:0xf bank_mask:0xf
    v_add_f32_dpp v38, v39, v38 quad_perm:[3,3,3,3] row_mask:0xf bank_mask:0xf
    v_add_f32_dpp v24, v26, v24 quad_perm:[2,2,2,2] row_mask:0xf bank_mask:0xf
    v_add_f32_dpp v28, v30, v28 quad_perm:[2,2,2,2] row_mask:0xf bank_mask:0xf
    v_add_f32_dpp v32, v34, v32 quad_perm:[2,2,2,2] row_mask:0xf bank_mask:0xf
    v_add_f32_dpp v36, v38, v36 quad_perm:[2,2,2,2] row_mask:0xf bank_mask:0xf
    v_cvt_pk_bf16_f32 v25, v24, v28
    v_cvt_pk_bf16_f32 v33, v32, v36
    v_lshlrev_b32 v24, 16, v25
    v_and_b32 v28, s39, v25
    v_mul_f32 v24, s50, v24
    v_mul_f32 v28, s50, v28
    v_max3_f32 v3, v3, v24, v28
    v_cvt_pk_bf16_f32 v62, v24, v28
    v_lshlrev_b32 v32, 16, v33
    v_and_b32 v36, s39, v33
    v_mul_f32 v32, s50, v32
    v_mul_f32 v36, s50, v36
    v_max3_f32 v3, v3, v32, v36
    v_cvt_pk_bf16_f32 v63, v32, v36
    v_mfma_f32_16x16x32_bf16 v[24:27], v[184:187], v[8:11], 0
    v_mfma_f32_16x16x32_bf16 v[28:31], v[188:191], v[8:11], 0
    v_mfma_f32_16x16x32_bf16 v[32:35], v[192:195], v[8:11], 0
    v_mfma_f32_16x16x32_bf16 v[36:39], v[196:199], v[8:11], 0
    s_waitcnt vmcnt(9)
    buffer_load_dwordx4 v[92:95], v2, s[44:47], s49 offen offset:3072 nt
    s_nop 2
    v_add_f32_dpp v24, v25, v24 quad_perm:[1,1,1,1] row_mask:0xf bank_mask:0xf
    v_add_f32_dpp v26, v27, v26 quad_perm:[3,3,3,3] row_mask:0xf bank_mask:0xf
    v_add_f32_dpp v28, v29, v28 quad_perm:[1,1,1,1] row_mask:0xf bank_mask:0xf
    v_add_f32_dpp v30, v31, v30 quad_perm:[3,3,3,3] row_mask:0xf bank_mask:0xf
    v_add_f32_dpp v32, v33, v32 quad_perm:[1,1,1,1] row_mask:0xf bank_mask:0xf
    v_add_f32_dpp v34, v35, v34 quad_perm:[3,3,3,3] row_mask:0xf bank_mask:0xf
    v_add_f32_dpp v36, v37, v36 quad_perm:[1,1,1,1] row_mask:0xf bank_mask:0xf
    v_add_f32_dpp v38, v39, v38 quad_perm:[3,3,3,3] row_mask:0xf bank_mask:0xf
    v_add_f32_dpp v24, v26, v24 quad_perm:[2,2,2,2] row_mask:0xf bank_mask:0xf
    v_add_f32_dpp v28, v30, v28 quad_perm:[2,2,2,2] row_mask:0xf bank_mask:0xf
    v_add_f32_dpp v32, v34, v32 quad_perm:[2,2,2,2] row_mask:0xf bank_mask:0xf
    v_add_f32_dpp v36, v38, v36 quad_perm:[2,2,2,2] row_mask:0xf bank_mask:0xf
    v_cvt_pk_bf16_f32 v25, v24, v28
    v_cvt_pk_bf16_f32 v33, v32, v36
    v_lshlrev_b32 v24, 16, v25
    v_and_b32 v28, s39, v25
    v_mul_f32 v24, s50, v24
    v_mul_f32 v28, s50, v28
    v_max3_f32 v3, v3, v24, v28
    v_cvt_pk_bf16_f32 v64, v24, v28
    v_lshlrev_b32 v32, 16, v33
    v_and_b32 v36, s39, v33
    v_mul_f32 v32, s50, v32
    v_mul_f32 v36, s50, v36
    v_max3_f32 v3, v3, v32, v36
    v_cvt_pk_bf16_f32 v65, v32, v36
    v_mfma_f32_16x16x32_bf16 v[24:27], v[200:203], v[8:11], 0
    v_mfma_f32_16x16x32_bf16 v[28:31], v[204:207], v[8:11], 0
    v_mfma_f32_16x16x32_bf16 v[32:35], v[208:211], v[8:11], 0
    v_mfma_f32_16x16x32_bf16 v[36:39], v[212:215], v[8:11], 0
    s_waitcnt vmcnt(9)
    s_add_u32 s54, s54, 0x4000
    s_and_b32 s54, s54, 0x3ffff
    s_add_u32 s49, s48, s54
    buffer_load_dwordx4 v[96:99], v2, s[44:47], s49 offen offset:0 nt
    v_add_f32_dpp v24, v25, v24 quad_perm:[1,1,1,1] row_mask:0xf bank_mask:0xf
    v_add_f32_dpp v26, v27, v26 quad_perm:[3,3,3,3] row_mask:0xf bank_mask:0xf
    v_add_f32_dpp v28, v29, v28 quad_perm:[1,1,1,1] row_mask:0xf bank_mask:0xf
    v_add_f32_dpp v30, v31, v30 quad_perm:[3,3,3,3] row_mask:0xf bank_mask:0xf
    v_add_f32_dpp v32, v33, v32 quad_perm:[1,1,1,1] row_mask:0xf bank_mask:0xf
    v_add_f32_dpp v34, v35, v34 quad_perm:[3,3,3,3] row_mask:0xf bank_mask:0xf
    v_add_f32_dpp v36, v37, v36 quad_perm:[1,1,1,1] row_mask:0xf bank_mask:0xf
    v_add_f32_dpp v38, v39, v38 quad_perm:[3,3,3,3] row_mask:0xf bank_mask:0xf
    v_add_f32_dpp v24, v26, v24 quad_perm:[2,2,2,2] row_mask:0xf bank_mask:0xf
    v_add_f32_dpp v28, v30, v28 quad_perm:[2,2,2,2] row_mask:0xf bank_mask:0xf
    v_add_f32_dpp v32, v34, v32 quad_perm:[2,2,2,2] row_mask:0xf bank_mask:0xf
    v_add_f32_dpp v36, v38, v36 quad_perm:[2,2,2,2] row_mask:0xf bank_mask:0xf
    v_cvt_pk_bf16_f32 v25, v24, v28
    v_cvt_pk_bf16_f32 v33, v32, v36
    v_lshlrev_b32 v24, 16, v25
    v_and_b32 v28, s39, v25
    v_mul_f32 v24, s50, v24
    v_mul_f32 v28, s50, v28
    v_max3_f32 v3, v3, v24, v28
    v_cvt_pk_bf16_f32 v66, v24, v28
    v_lshlrev_b32 v32, 16, v33
    v_and_b32 v36, s39, v33
    v_mul_f32 v32, s50, v32
    v_mul_f32 v36, s50, v36
    v_max3_f32 v3, v3, v32, v36
    v_cvt_pk_bf16_f32 v67, v32, v36
    v_mfma_f32_16x16x32_bf16 v[24:27], v[216:219], v[8:11], 0
    v_mfma_f32_16x16x32_bf16 v[28:31], v[220:223], v[8:11], 0
    v_mfma_f32_16x16x32_bf16 v[32:35], v[224:227], v[8:11], 0
    v_mfma_f32_16x16x32_bf16 v[36:39], v[228:231], v[8:11], 0
    ds_read_b128 v[100:103], v7 offset:0
    ds_read_b128 v[104:107], v7 offset:1024
    ds_read_b128 v[108:111], v7 offset:2048
    ds_read_b128 v[112:115], v7 offset:3072
    s_waitcnt vmcnt(9)
    buffer_load_dwordx4 v[116:119], v2, s[44:47], s49 offen offset:1024 nt
    v_add_f32_dpp v24, v25, v24 quad_perm:[1,1,1,1] row_mask:0xf bank_mask:0xf
    v_add_f32_dpp v26, v27, v26 quad_perm:[3,3,3,3] row_mask:0xf bank_mask:0xf
    v_add_f32_dpp v28, v29, v28 quad_perm:[1,1,1,1] row_mask:0xf bank_mask:0xf
    v_add_f32_dpp v30, v31, v30 quad_perm:[3,3,3,3] row_mask:0xf bank_mask:0xf
    v_add_f32_dpp v32, v33, v32 quad_perm:[1,1,1,1] row_mask:0xf bank_mask:0xf
    v_add_f32_dpp v34, v35, v34 quad_perm:[3,3,3,3] row_mask:0xf bank_mask:0xf
    v_add_f32_dpp v36, v37, v36 quad_perm:[1,1,1,1] row_mask:0xf bank_mask:0xf
    v_add_f32_dpp v38, v39, v38 quad_perm:[3,3,3,3] row_mask:0xf bank_mask:0xf
    v_add_f32_dpp v24, v26, v24 quad_perm:[2,2,2,2] row_mask:0xf bank_mask:0xf
    v_add_f32_dpp v28, v30, v28 quad_perm:[2,2,2,2] row_mask:0xf bank_mask:0xf
    v_add_f32_dpp v32, v34, v32 quad_perm:[2,2,2,2] row_mask:0xf bank_mask:0xf
    v_add_f32_dpp v36, v38, v36 quad_perm:[2,2,2,2] row_mask:0xf bank_mask:0xf
    v_cvt_pk_bf16_f32 v25, v24, v28
    v_cvt_pk_bf16_f32 v33, v32, v36
    v_lshlrev_b32 v24, 16, v25
    v_and_b32 v28, s39, v25
    v_mul_f32 v24, s50, v24
    v_mul_f32 v28, s50, v28
    v_max3_f32 v3, v3, v24, v28
    v_cvt_pk_bf16_f32 v68, v24, v28
    v_lshlrev_b32 v32, 16, v33
    v_and_b32 v36, s39, v33
    v_mul_f32 v32, s50, v32
    v_mul_f32 v36, s50, v36
    v_max3_f32 v3, v3, v32, v36
    v_cvt_pk_bf16_f32 v69, v32, v36
    v_mfma_f32_16x16x32_bf16 v[24:27], v[232:235], v[8:11], 0
    v_mfma_f32_16x16x32_bf16 v[28:31], v[236:239], v[8:11], 0
    v_mfma_f32_16x16x32_bf16 v[32:35], v[240:243], v[8:11], 0
    v_mfma_f32_16x16x32_bf16 v[36:39], v[244:247], v[8:11], 0
    s_waitcnt vmcnt(9)
    buffer_load_dwordx4 v[120:123], v2, s[44:47], s49 offen offset:2048 nt
    s_nop 2
    v_add_f32_dpp v24, v25, v24 quad_perm:[1,1,1,1] row_mask:0xf bank_mask:0xf
    v_add_f32_dpp v26, v27, v26 quad_perm:[3,3,3,3] row_mask:0xf bank_mask:0xf
    v_add_f32_dpp v28, v29, v28 quad_perm:[1,1,1,1] row_mask:0xf bank_mask:0xf
    v_add_f32_dpp v30, v31, v30 quad_perm:[3,3,3,3] row_mask:0xf bank_mask:0xf
    v_add_f32_dpp v32, v33, v32 quad_perm:[1,1,1,1] row_mask:0xf bank_mask:0xf
    v_add_f32_dpp v34, v35, v34 quad_perm:[3,3,3,3] row_mask:0xf bank_mask:0xf
    v_add_f32_dpp v36, v37, v36 quad_perm:[1,1,1,1] row_mask:0xf bank_mask:0xf
    v_add_f32_dpp v38, v39, v38 quad_perm:[3,3,3,3] row_mask:0xf bank_mask:0xf
    v_add_f32_dpp v24, v26, v24 quad_perm:[2,2,2,2] row_mask:0xf bank_mask:0xf
    v_add_f32_dpp v28, v30, v28 quad_perm:[2,2,2,2] row_mask:0xf bank_mask:0xf
    v_add_f32_dpp v32, v34, v32 quad_perm:[2,2,2,2] row_mask:0xf bank_mask:0xf
    v_add_f32_dpp v36, v38, v36 quad_perm:[2,2,2,2] row_mask:0xf bank_mask:0xf
    v_cvt_pk_bf16_f32 v25, v24, v28
    v_cvt_pk_bf16_f32 v33, v32, v36
    v_lshlrev_b32 v24, 16, v25
    v_and_b32 v28, s39, v25
    v_mul_f32 v24, s50, v24
    v_mul_f32 v28, s50, v28
    v_max3_f32 v3, v3, v24, v28
    v_cvt_pk_bf16_f32 v70, v24, v28
    v_lshlrev_b32 v32, 16, v33
    v_and_b32 v36, s39, v33
    v_mul_f32 v32, s50, v32
    v_mul_f32 v36, s50, v36
    v_max3_f32 v3, v3, v32, v36
    v_cvt_pk_bf16_f32 v71, v32, v36
    s_waitcnt lgkmcnt(0)
    v_mfma_f32_16x16x32_bf16 v[24:27], v[100:103], v[8:11], 0
    v_mfma_f32_16x16x32_bf16 v[28:31], v[104:107], v[8:11], 0
    v_mfma_f32_16x16x32_bf16 v[32:35], v[108:111], v[8:11], 0
    v_mfma_f32_16x16x32_bf16 v[36:39], v[112:115], v[8:11], 0
    ds_read_b128 v[124:127], v7 offset:4096
    ds_read_b128 v[128:131], v7 offset:5120
    ds_read_b128 v[132:135], v7 offset:6144
    ds_read_b128 v[136:139], v7 offset:7168
    s_waitcnt vmcnt(9)
    buffer_load_dwordx4 v[140:143], v2, s[44:47], s49 offen offset:3072 nt
    v_add_f32_dpp v24, v25, v24 quad_perm:[1,1,1,1] row_mask:0xf bank_mask:0xf
    v_add_f32_dpp v26, v27, v26 quad_perm:[3,3,3,3] row_mask:0xf bank_mask:0xf
    v_add_f32_dpp v28, v29, v28 quad_perm:[1,1,1,1] row_mask:0xf bank_mask:0xf
    v_add_f32_dpp v30, v31, v30 quad_perm:[3,3,3,3] row_mask:0xf bank_mask:0xf
    v_add_f32_dpp v32, v33, v32 quad_perm:[1,1,1,1] row_mask:0xf bank_mask:0xf
    v_add_f32_dpp v34, v35, v34 quad_perm:[3,3,3,3] row_mask:0xf bank_mask:0xf
    v_add_f32_dpp v36, v37, v36 quad_perm:[1,1,1,1] row_mask:0xf bank_mask:0xf
    v_add_f32_dpp v38, v39, v38 quad_perm:[3,3,3,3] row_mask:0xf bank_mask:0xf
    v_add_f32_dpp v24, v26, v24 quad_perm:[2,2,2,2] row_mask:0xf bank_mask:0xf
    v_add_f32_dpp v28, v30, v28 quad_perm:[2,2,2,2] row_mask:0xf bank_mask:0xf
    v_add_f32_dpp v32, v34, v32 quad_perm:[2,2,2,2] row_mask:0xf bank_mask:0xf
    v_add_f32_dpp v36, v38, v36 quad_perm:[2,2,2,2] row_mask:0xf bank_mask:0xf
    v_cvt_pk_bf16_f32 v25, v24, v28
    v_cvt_pk_bf16_f32 v33, v32, v36
    v_lshlrev_b32 v24, 16, v25
    v_and_b32 v28, s39, v25
    v_mul_f32 v24, s50, v24
    v_mul_f32 v28, s50, v28
    v_max3_f32 v3, v3, v24, v28
    v_cvt_pk_bf16_f32 v40, v24, v28
    v_lshlrev_b32 v32, 16, v33
    v_and_b32 v36, s39, v33
    v_mul_f32 v32, s50, v32
    v_mul_f32 v36, s50, v36
    v_max3_f32 v3, v3, v32, v36
    v_cvt_pk_bf16_f32 v41, v32, v36
    s_waitcnt lgkmcnt(0)
    v_mfma_f32_16x16x32_bf16 v[24:27], v[124:127], v[8:11], 0
    v_mfma_f32_16x16x32_bf16 v[28:31], v[128:131], v[8:11], 0
    v_mfma_f32_16x16x32_bf16 v[32:35], v[132:135], v[8:11], 0
    v_mfma_f32_16x16x32_bf16 v[36:39], v[136:139], v[8:11], 0
    ds_read_b128 v[144:147], v7 offset:8192
    ds_read_b128 v[148:151], v7 offset:9216
    ds_read_b128 v[152:155], v7 offset:10240
    ds_read_b128 v[156:159], v7 offset:11264
    s_waitcnt vmcnt(9)
    s_add_u32 s54, s54, 0x4000
    s_and_b32 s54, s54, 0x3ffff
    s_add_u32 s49, s48, s54
    buffer_load_dwordx4 v[160:163], v2, s[44:47], s49 offen offset:0 nt
    v_add_f32_dpp v24, v25, v24 quad_perm:[1,1,1,1] row_mask:0xf bank_mask:0xf
    v_add_f32_dpp v26, v27, v26 quad_perm:[3,3,3,3] row_mask:0xf bank_mask:0xf
    v_add_f32_dpp v28, v29, v28 quad_perm:[1,1,1,1] row_mask:0xf bank_mask:0xf
    v_add_f32_dpp v30, v31, v30 quad_perm:[3,3,3,3] row_mask:0xf bank_mask:0xf
    v_add_f32_dpp v32, v33, v32 quad_perm:[1,1,1,1] row_mask:0xf bank_mask:0xf
    v_add_f32_dpp v34, v35, v34 quad_perm:[3,3,3,3] row_mask:0xf bank_mask:0xf
    v_add_f32_dpp v36, v37, v36 quad_perm:[1,1,1,1] row_mask:0xf bank_mask:0xf
    v_add_f32_dpp v38, v39, v38 quad_perm:[3,3,3,3] row_mask:0xf bank_mask:0xf
    v_add_f32_dpp v24, v26, v24 quad_perm:[2,2,2,2] row_mask:0xf bank_mask:0xf
    v_add_f32_dpp v28, v30, v28 quad_perm:[2,2,2,2] row_mask:0xf bank_mask:0xf
    v_add_f32_dpp v32, v34, v32 quad_perm:[2,2,2,2] row_mask:0xf bank_mask:0xf
    v_add_f32_dpp v36, v38, v36 quad_perm:[2,2,2,2] row_mask:0xf bank_mask:0xf
    v_cvt_pk_bf16_f32 v25, v24, v28
    v_cvt_pk_bf16_f32 v33, v32, v36
    v_lshlrev_b32 v24, 16, v25
    v_and_b32 v28, s39, v25
    v_mul_f32 v24, s50, v24
    v_mul_f32 v28, s50, v28
    v_max3_f32 v3, v3, v24, v28
    v_cvt_pk_bf16_f32 v42, v24, v28
    v_lshlrev_b32 v32, 16, v33
    v_and_b32 v36, s39, v33
    v_mul_f32 v32, s50, v32
    v_mul_f32 v36, s50, v36
    v_max3_f32 v3, v3, v32, v36
    v_cvt_pk_bf16_f32 v43, v32, v36
    s_waitcnt lgkmcnt(0)
    v_mfma_f32_16x16x32_bf16 v[24:27], v[144:147], v[8:11], 0
    v_mfma_f32_16x16x32_bf16 v[28:31], v[148:151], v[8:11], 0
    v_mfma_f32_16x16x32_bf16 v[32:35], v[152:155], v[8:11], 0
    v_mfma_f32_16x16x32_bf16 v[36:39], v[156:159], v[8:11], 0
    ds_read_b128 v[164:167], v7 offset:12288
    ds_read_b128 v[168:171], v7 offset:13312
    ds_read_b128 v[172:175], v7 offset:14336
    ds_read_b128 v[176:179], v7 offset:15360
    s_waitcnt vmcnt(9)
    buffer_load_dwordx4 v[180:183], v2, s[44:47], s49 offen offset:1024 nt
    v_add_f32_dpp v24, v25, v24 quad_perm:[1,1,1,1] row_mask:0xf bank_mask:0xf
    v_add_f32_dpp v26, v27, v26 quad_perm:[3,3,3,3] row_mask:0xf bank_mask:0xf
    v_add_f32_dpp v28, v29, v28 quad_perm:[1,1,1,1] row_mask:0xf bank_mask:0xf
    v_add_f32_dpp v30, v31, v30 quad_perm:[3,3,3,3] row_mask:0xf bank_mask:0xf
    v_add_f32_dpp v32, v33, v32 quad_perm:[1,1,1,1] row_mask:0xf bank_mask:0xf
    v_add_f32_dpp v34, v35, v34 quad_perm:[3,3,3,3] row_mask:0xf bank_mask:0xf
    v_add_f32_dpp v36, v37, v36 quad_perm:[1,1,1,1] row_mask:0xf bank_mask:0xf
    v_add_f32_dpp v38, v39, v38 quad_perm:[3,3,3,3] row_mask:0xf bank_mask:0xf
    v_add_f32_dpp v24, v26, v24 quad_perm:[2,2,2,2] row_mask:0xf bank_mask:0xf
    v_add_f32_dpp v28, v30, v28 quad_perm:[2,2,2,2] row_mask:0xf bank_mask:0xf
    v_add_f32_dpp v32, v34, v32 quad_perm:[2,2,2,2] row_mask:0xf bank_mask:0xf
    v_add_f32_dpp v36, v38, v36 quad_perm:[2,2,2,2] row_mask:0xf bank_mask:0xf
    v_cvt_pk_bf16_f32 v25, v24, v28
    v_cvt_pk_bf16_f32 v33, v32, v36
    v_lshlrev_b32 v24, 16, v25
    v_and_b32 v28, s39, v25
    v_mul_f32 v24, s50, v24
    v_mul_f32 v28, s50, v28
    v_max3_f32 v3, v3, v24, v28
    v_cvt_pk_bf16_f32 v44, v24, v28
    v_lshlrev_b32 v32, 16, v33
    v_and_b32 v36, s39, v33
    v_mul_f32 v32, s50, v32
    v_mul_f32 v36, s50, v36
    v_max3_f32 v3, v3, v32, v36
    v_cvt_pk_bf16_f32 v45, v32, v36
    s_waitcnt lgkmcnt(0)
    v_mfma_f32_16x16x32_bf16 v[24:27], v[164:167], v[8:11], 0
    v_mfma_f32_16x16x32_bf16 v[28:31], v[168:171], v[8:11], 0
    v_mfma_f32_16x16x32_bf16 v[32:35], v[172:175], v[8:11], 0
    v_mfma_f32_16x16x32_bf16 v[36:39], v[176:179], v[8:11], 0
    ds_read_b128 v[184:187], v7 offset:16384
    ds_read_b128 v[188:191], v7 offset:17408
    ds_read_b128 v[192:195], v7 offset:18432
    ds_read_b128 v[196:199], v7 offset:19456
    s_waitcnt vmcnt(9)
    buffer_load_dwordx4 v[200:203], v2, s[44:47], s49 offen offset:2048 nt
    v_add_f32_dpp v24, v25, v24 quad_perm:[1,1,1,1] row_mask:0xf bank_mask:0xf
    v_add_f32_dpp v26, v27, v26 quad_perm:[3,3,3,3] row_mask:0xf bank_mask:0xf
    v_add_f32_dpp v28, v29, v28 quad_perm:[1,1,1,1] row_mask:0xf bank_mask:0xf
    v_add_f32_dpp v30, v31, v30 quad_perm:[3,3,3,3] row_mask:0xf bank_mask:0xf
    v_add_f32_dpp v32, v33, v32 quad_perm:[1,1,1,1] row_mask:0xf bank_mask:0xf
    v_add_f32_dpp v34, v35, v34 quad_perm:[3,3,3,3] row_mask:0xf bank_mask:0xf
    v_add_f32_dpp v36, v37, v36 quad_perm:[1,1,1,1] row_mask:0xf bank_mask:0xf
    v_add_f32_dpp v38, v39, v38 quad_perm:[3,3,3,3] row_mask:0xf bank_mask:0xf
    v_add_f32_dpp v24, v26, v24 quad_perm:[2,2,2,2] row_mask:0xf bank_mask:0xf
    v_add_f32_dpp v28, v30, v28 quad_perm:[2,2,2,2] row_mask:0xf bank_mask:0xf
    v_add_f32_dpp v32, v34, v32 quad_perm:[2,2,2,2] row_mask:0xf bank_mask:0xf
    v_add_f32_dpp v36, v38, v36 quad_perm:[2,2,2,2] row_mask:0xf bank_mask:0xf
    v_cvt_pk_bf16_f32 v25, v24, v28
    v_cvt_pk_bf16_f32 v33, v32, v36
    v_lshlrev_b32 v24, 16, v25
    v_and_b32 v28, s39, v25
    v_mul_f32 v24, s50, v24
    v_mul_f32 v28, s50, v28
    v_max3_f32 v3, v3, v24, v28
    v_cvt_pk_bf16_f32 v46, v24, v28
    v_lshlrev_b32 v32, 16, v33
    v_and_b32 v36, s39, v33
    v_mul_f32 v32, s50, v32
    v_mul_f32 v36, s50, v36
    v_max3_f32 v3, v3, v32, v36
    v_cvt_pk_bf16_f32 v47, v32, v36
    s_waitcnt lgkmcnt(0)
    v_mfma_f32_16x16x32_bf16 v[24:27], v[184:187], v[8:11], 0
    v_mfma_f32_16x16x32_bf16 v[28:31], v[188:191], v[8:11], 0
    v_mfma_f32_16x16x32_bf16 v[32:35], v[192:195], v[8:11], 0
    v_mfma_f32_16x16x32_bf16 v[36:39], v[196:199], v[8:11], 0
    s_waitcnt vmcnt(9)
    buffer_load_dwordx4 v[204:207], v2, s[44:47], s49 offen offset:3072 nt
    s_nop 2
    v_add_f32_dpp v24, v25, v24 quad_perm:[1,1,1,1] row_mask:0xf bank_mask:0xf
    v_add_f32_dpp v26, v27, v26 quad_perm:[3,3,3,3] row_mask:0xf bank_mask:0xf
    v_add_f32_dpp v28, v29, v28 quad_perm:[1,1,1,1] row_mask:0xf bank_mask:0xf
    v_add_f32_dpp v30, v31, v30 quad_perm:[3,3,3,3] row_mask:0xf bank_mask:0xf
    v_add_f32_dpp v32, v33, v32 quad_perm:[1,1,1,1] row_mask:0xf bank_mask:0xf
    v_add_f32_dpp v34, v35, v34 quad_perm:[3,3,3,3] row_mask:0xf bank_mask:0xf
    v_add_f32_dpp v36, v37, v36 quad_perm:[1,1,1,1] row_mask:0xf bank_mask:0xf
    v_add_f32_dpp v38, v39, v38 quad_perm:[3,3,3,3] row_mask:0xf bank_mask:0xf
    v_add_f32_dpp v24, v26, v24 quad_perm:[2,2,2,2] row_mask:0xf bank_mask:0xf
    v_add_f32_dpp v28, v30, v28 quad_perm:[2,2,2,2] row_mask:0xf bank_mask:0xf
    v_add_f32_dpp v32, v34, v32 quad_perm:[2,2,2,2] row_mask:0xf bank_mask:0xf
    v_add_f32_dpp v36, v38, v36 quad_perm:[2,2,2,2] row_mask:0xf bank_mask:0xf
    v_cvt_pk_bf16_f32 v25, v24, v28
    v_cvt_pk_bf16_f32 v33, v32, v36
    v_lshlrev_b32 v24, 16, v25
    v_and_b32 v28, s39, v25
    v_mul_f32 v24, s50, v24
    v_mul_f32 v28, s50, v28
    v_max3_f32 v3, v3, v24, v28
    v_cvt_pk_bf16_f32 v48, v24, v28
    v_lshlrev_b32 v32, 16, v33
    v_and_b32 v36, s39, v33
    v_mul_f32 v32, s50, v32
    v_mul_f32 v36, s50, v36
    v_max3_f32 v3, v3, v32, v36
    v_cvt_pk_bf16_f32 v49, v32, v36
    s_nop 0
    v_mov_b32_dpp v3, v3 quad_perm:[0,0,0,0] row_mask:0xf bank_mask:0xf
    v_mov_b32 v6, v3
    s_nop 1
    v_permlane16_swap_b32 v3, v6
    v_max_f32 v3, v3, v6
    v_mov_b32 v6, v3
    s_nop 1
    v_permlane32_swap_b32 v3, v6
    v_max_f32 v3, v3, v6
    v_cvt_pk_bf16_f32 v3, v3, v3
    v_lshlrev_b32 v3, 16, v3
    v_mul_f32 v5, s51, v3
    v_sub_f32 v5, 0, v5
    v_lshlrev_b32 v24, 16, v40
    v_and_b32 v25, s39, v40
    v_fma_f32 v24, v24, s51, v5
    v_fma_f32 v25, v25, s51, v5
    v_lshlrev_b32 v28, 16, v41
    v_and_b32 v29, s39, v41
    v_fma_f32 v28, v28, s51, v5
    v_fma_f32 v29, v29, s51, v5
    v_lshlrev_b32 v32, 16, v42
    v_and_b32 v33, s39, v42
    v_fma_f32 v32, v32, s51, v5
    v_fma_f32 v33, v33, s51, v5
    v_lshlrev_b32 v36, 16, v43
    v_and_b32 v37, s39, v43
    v_fma_f32 v36, v36, s51, v5
    v_fma_f32 v37, v37, s51, v5
    v_exp_f32_dpp v26, v24 quad_perm:[0,0,0,0] row_mask:0xf bank_mask:0xf
    v_exp_f32_dpp v27, v25 quad_perm:[0,0,0,0] row_mask:0xf bank_mask:0xf
    v_exp_f32_dpp v30, v28 quad_perm:[0,0,0,0] row_mask:0xf bank_mask:0xf
    v_exp_f32_dpp v31, v29 quad_perm:[0,0,0,0] row_mask:0xf bank_mask:0xf
    v_exp_f32_dpp v34, v32 quad_perm:[0,0,0,0] row_mask:0xf bank_mask:0xf
    v_exp_f32_dpp v35, v33 quad_perm:[0,0,0,0] row_mask:0xf bank_mask:0xf
    v_exp_f32_dpp v38, v36 quad_perm:[0,0,0,0] row_mask:0xf bank_mask:0xf
    v_exp_f32_dpp v39, v37 quad_perm:[0,0,0,0] row_mask:0xf bank_mask:0xf
    v_add_f32 v4, v4, v26
    v_cvt_pk_bf16_f32 v40, v26, v27
    v_add_f32 v4, v4, v27
    v_add_f32 v4, v4, v30
    v_cvt_pk_bf16_f32 v41, v30, v31
    v_add_f32 v4, v4, v31
    v_add_f32 v4, v4, v34
    v_cvt_pk_bf16_f32 v42, v34, v35
    v_add_f32 v4, v4, v35
    v_add_f32 v4, v4, v38
    v_cvt_pk_bf16_f32 v43, v38, v39
    v_add_f32 v4, v4, v39
    s_waitcnt vmcnt(9)
    s_add_u32 s54, s54, 0x4000
    s_and_b32 s54, s54, 0x3ffff
    s_add_u32 s49, s48, s54
    buffer_load_dwordx4 v[208:211], v2, s[44:47], s49 offen offset:0 nt
    v_lshlrev_b32 v24, 16, v44
    v_and_b32 v25, s39, v44
    v_fma_f32 v24, v24, s51, v5
    v_fma_f32 v25, v25, s51, v5
    v_lshlrev_b32 v28, 16, v45
    v_and_b32 v29, s39, v45
    v_fma_f32 v28, v28, s51, v5
    v_fma_f32 v29, v29, s51, v5
    v_lshlrev_b32 v32, 16, v46
    v_and_b32 v33, s39, v46
    v_fma_f32 v32, v32, s51, v5
    v_fma_f32 v33, v33, s51, v5
    v_lshlrev_b32 v36, 16, v47
    v_and_b32 v37, s39, v47
    v_fma_f32 v36, v36, s51, v5
    v_fma_f32 v37, v37, s51, v5
    v_exp_f32_dpp v26, v24 quad_perm:[0,0,0,0] row_mask:0xf bank_mask:0xf
    v_exp_f32_dpp v27, v25 quad_perm:[0,0,0,0] row_mask:0xf bank_mask:0xf
    v_exp_f32_dpp v30, v28 quad_perm:[0,0,0,0] row_mask:0xf bank_mask:0xf
    v_exp_f32_dpp v31, v29 quad_perm:[0,0,0,0] row_mask:0xf bank_mask:0xf
    v_exp_f32_dpp v34, v32 quad_perm:[0,0,0,0] row_mask:0xf bank_mask:0xf
    v_exp_f32_dpp v35, v33 quad_perm:[0,0,0,0] row_mask:0xf bank_mask:0xf
    v_exp_f32_dpp v38, v36 quad_perm:[0,0,0,0] row_mask:0xf bank_mask:0xf
    v_exp_f32_dpp v39, v37 quad_perm:[0,0,0,0] row_mask:0xf bank_mask:0xf
    v_add_f32 v4, v4, v26
    v_cvt_pk_bf16_f32 v44, v26, v27
    v_add_f32 v4, v4, v27
    v_add_f32 v4, v4, v30
    v_cvt_pk_bf16_f32 v45, v30, v31
    v_add_f32 v4, v4, v31
    v_add_f32 v4, v4, v34
    v_cvt_pk_bf16_f32 v46, v34, v35
    v_add_f32 v4, v4, v35
    v_add_f32 v4, v4, v38
    v_cvt_pk_bf16_f32 v47, v38, v39
    v_add_f32 v4, v4, v39
    s_waitcnt vmcnt(9)
    buffer_load_dwordx4 v[212:215], v2, s[44:47], s49 offen offset:1024 nt
    v_lshlrev_b32 v24, 16, v48
    v_and_b32 v25, s39, v48
    v_fma_f32 v24, v24, s51, v5
    v_fma_f32 v25, v25, s51, v5
    v_lshlrev_b32 v28, 16, v49
    v_and_b32 v29, s39, v49
    v_fma_f32 v28, v28, s51, v5
    v_fma_f32 v29, v29, s51, v5
    v_lshlrev_b32 v32, 16, v50
    v_and_b32 v33, s39, v50
    v_fma_f32 v32, v32, s51, v5
    v_fma_f32 v33, v33, s51, v5
    v_lshlrev_b32 v36, 16, v51
    v_and_b32 v37, s39, v51
    v_fma_f32 v36, v36, s51, v5
    v_fma_f32 v37, v37, s51, v5
    v_exp_f32_dpp v26, v24 quad_perm:[0,0,0,0] row_mask:0xf bank_mask:0xf
    v_exp_f32_dpp v27, v25 quad_perm:[0,0,0,0] row_mask:0xf bank_mask:0xf
    v_exp_f32_dpp v30, v28 quad_perm:[0,0,0,0] row_mask:0xf bank_mask:0xf
    v_exp_f32_dpp v31, v29 quad_perm:[0,0,0,0] row_mask:0xf bank_mask:0xf
    v_exp_f32_dpp v34, v32 quad_perm:[0,0,0,0] row_mask:0xf bank_mask:0xf
    v_exp_f32_dpp v35, v33 quad_perm:[0,0,0,0] row_mask:0xf bank_mask:0xf
    v_exp_f32_dpp v38, v36 quad_perm:[0,0,0,0] row_mask:0xf bank_mask:0xf
    v_exp_f32_dpp v39, v37 quad_perm:[0,0,0,0] row_mask:0xf bank_mask:0xf
    v_add_f32 v4, v4, v26
    v_cvt_pk_bf16_f32 v48, v26, v27
    v_add_f32 v4, v4, v27
    v_add_f32 v4, v4, v30
    v_cvt_pk_bf16_f32 v49, v30, v31
    v_add_f32 v4, v4, v31
    v_add_f32 v4, v4, v34
    v_cvt_pk_bf16_f32 v50, v34, v35
    v_add_f32 v4, v4, v35
    v_add_f32 v4, v4, v38
    v_cvt_pk_bf16_f32 v51, v38, v39
    v_add_f32 v4, v4, v39
    s_waitcnt vmcnt(9)
    buffer_load_dwordx4 v[216:219], v2, s[44:47], s49 offen offset:2048 nt
    v_lshlrev_b32 v24, 16, v52
    v_and_b32 v25, s39, v52
    v_fma_f32 v24, v24, s51, v5
    v_fma_f32 v25, v25, s51, v5
    v_lshlrev_b32 v28, 16, v53
    v_and_b32 v29, s39, v53
    v_fma_f32 v28, v28, s51, v5
    v_fma_f32 v29, v29, s51, v5
    v_lshlrev_b32 v32, 16, v54
    v_and_b32 v33, s39, v54
    v_fma_f32 v32, v32, s51, v5
    v_fma_f32 v33, v33, s51, v5
    v_lshlrev_b32 v36, 16, v55
    v_and_b32 v37, s39, v55
    v_fma_f32 v36, v36, s51, v5
    v_fma_f32 v37, v37, s51, v5
    v_exp_f32_dpp v26, v24 quad_perm:[0,0,0,0] row_mask:0xf bank_mask:0xf
    v_exp_f32_dpp v27, v25 quad_perm:[0,0,0,0] row_mask:0xf bank_mask:0xf
    v_exp_f32_dpp v30, v28 quad_perm:[0,0,0,0] row_mask:0xf bank_mask:0xf
    v_exp_f32_dpp v31, v29 quad_perm:[0,0,0,0] row_mask:0xf bank_mask:0xf
    v_exp_f32_dpp v34, v32 quad_perm:[0,0,0,0] row_mask:0xf bank_mask:0xf
    v_exp_f32_dpp v35, v33 quad_perm:[0,0,0,0] row_mask:0xf bank_mask:0xf
    v_exp_f32_dpp v38, v36 quad_perm:[0,0,0,0] row_mask:0xf bank_mask:0xf
    v_exp_f32_dpp v39, v37 quad_perm:[0,0,0,0] row_mask:0xf bank_mask:0xf
    v_add_f32 v4, v4, v26
    v_cvt_pk_bf16_f32 v52, v26, v27
    v_add_f32 v4, v4, v27
    v_add_f32 v4, v4, v30
    v_cvt_pk_bf16_f32 v53, v30, v31
    v_add_f32 v4, v4, v31
    v_add_f32 v4, v4, v34
    v_cvt_pk_bf16_f32 v54, v34, v35
    v_add_f32 v4, v4, v35
    v_add_f32 v4, v4, v38
    v_cvt_pk_bf16_f32 v55, v38, v39
    v_add_f32 v4, v4, v39
    s_waitcnt vmcnt(9)
    buffer_load_dwordx4 v[220:223], v2, s[44:47], s49 offen offset:3072 nt
    v_lshlrev_b32 v24, 16, v56
    v_and_b32 v25, s39, v56
    v_fma_f32 v24, v24, s51, v5
    v_fma_f32 v25, v25, s51, v5
    v_lshlrev_b32 v28, 16, v57
    v_and_b32 v29, s39, v57
    v_fma_f32 v28, v28, s51, v5
    v_fma_f32 v29, v29, s51, v5
    v_lshlrev_b32 v32, 16, v58
    v_and_b32 v33, s39, v58
    v_fma_f32 v32, v32, s51, v5
    v_fma_f32 v33, v33, s51, v5
    v_lshlrev_b32 v36, 16, v59
    v_and_b32 v37, s39, v59
    v_fma_f32 v36, v36, s51, v5
    v_fma_f32 v37, v37, s51, v5
    v_exp_f32_dpp v26, v24 quad_perm:[0,0,0,0] row_mask:0xf bank_mask:0xf
    v_exp_f32_dpp v27, v25 quad_perm:[0,0,0,0] row_mask:0xf bank_mask:0xf
    v_exp_f32_dpp v30, v28 quad_perm:[0,0,0,0] row_mask:0xf bank_mask:0xf
    v_exp_f32_dpp v31, v29 quad_perm:[0,0,0,0] row_mask:0xf bank_mask:0xf
    v_exp_f32_dpp v34, v32 quad_perm:[0,0,0,0] row_mask:0xf bank_mask:0xf
    v_exp_f32_dpp v35, v33 quad_perm:[0,0,0,0] row_mask:0xf bank_mask:0xf
    v_exp_f32_dpp v38, v36 quad_perm:[0,0,0,0] row_mask:0xf bank_mask:0xf
    v_exp_f32_dpp v39, v37 quad_perm:[0,0,0,0] row_mask:0xf bank_mask:0xf
    v_add_f32 v4, v4, v26
    v_cvt_pk_bf16_f32 v56, v26, v27
    v_add_f32 v4, v4, v27
    v_add_f32 v4, v4, v30
    v_cvt_pk_bf16_f32 v57, v30, v31
    v_add_f32 v4, v4, v31
    v_add_f32 v4, v4, v34
    v_cvt_pk_bf16_f32 v58, v34, v35
    v_add_f32 v4, v4, v35
    v_add_f32 v4, v4, v38
    v_cvt_pk_bf16_f32 v59, v38, v39
    v_add_f32 v4, v4, v39
    s_waitcnt vmcnt(9)
    s_add_u32 s54, s54, 0x4000
    s_and_b32 s54, s54, 0x3ffff
    s_add_u32 s49, s48, s54
    buffer_load_dwordx4 v[224:227], v2, s[44:47], s49 offen offset:0 nt
    v_lshlrev_b32 v24, 16, v60
    v_and_b32 v25, s39, v60
    v_fma_f32 v24, v24, s51, v5
    v_fma_f32 v25, v25, s51, v5
    v_lshlrev_b32 v28, 16, v61
    v_and_b32 v29, s39, v61
    v_fma_f32 v28, v28, s51, v5
    v_fma_f32 v29, v29, s51, v5
    v_lshlrev_b32 v32, 16, v62
    v_and_b32 v33, s39, v62
    v_fma_f32 v32, v32, s51, v5
    v_fma_f32 v33, v33, s51, v5
    v_lshlrev_b32 v36, 16, v63
    v_and_b32 v37, s39, v63
    v_fma_f32 v36, v36, s51, v5
    v_fma_f32 v37, v37, s51, v5
    v_exp_f32_dpp v26, v24 quad_perm:[0,0,0,0] row_mask:0xf bank_mask:0xf
    v_exp_f32_dpp v27, v25 quad_perm:[0,0,0,0] row_mask:0xf bank_mask:0xf
    v_exp_f32_dpp v30, v28 quad_perm:[0,0,0,0] row_mask:0xf bank_mask:0xf
    v_exp_f32_dpp v31, v29 quad_perm:[0,0,0,0] row_mask:0xf bank_mask:0xf
    v_exp_f32_dpp v34, v32 quad_perm:[0,0,0,0] row_mask:0xf bank_mask:0xf
    v_exp_f32_dpp v35, v33 quad_perm:[0,0,0,0] row_mask:0xf bank_mask:0xf
    v_exp_f32_dpp v38, v36 quad_perm:[0,0,0,0] row_mask:0xf bank_mask:0xf
    v_exp_f32_dpp v39, v37 quad_perm:[0,0,0,0] row_mask:0xf bank_mask:0xf
    v_add_f32 v4, v4, v26
    v_cvt_pk_bf16_f32 v60, v26, v27
    v_add_f32 v4, v4, v27
    v_add_f32 v4, v4, v30
    v_cvt_pk_bf16_f32 v61, v30, v31
    v_add_f32 v4, v4, v31
    v_add_f32 v4, v4, v34
    v_cvt_pk_bf16_f32 v62, v34, v35
    v_add_f32 v4, v4, v35
    v_add_f32 v4, v4, v38
    v_cvt_pk_bf16_f32 v63, v38, v39
    v_add_f32 v4, v4, v39
    s_waitcnt vmcnt(9)
    buffer_load_dwordx4 v[228:231], v2, s[44:47], s49 offen offset:1024 nt
    v_lshlrev_b32 v24, 16, v64
    v_and_b32 v25, s39, v64
    v_fma_f32 v24, v24, s51, v5
    v_fma_f32 v25, v25, s51, v5
    v_lshlrev_b32 v28, 16, v65
    v_and_b32 v29, s39, v65
    v_fma_f32 v28, v28, s51, v5
    v_fma_f32 v29, v29, s51, v5
    v_lshlrev_b32 v32, 16, v66
    v_and_b32 v33, s39, v66
    v_fma_f32 v32, v32, s51, v5
    v_fma_f32 v33, v33, s51, v5
    v_lshlrev_b32 v36, 16, v67
    v_and_b32 v37, s39, v67
    v_fma_f32 v36, v36, s51, v5
    v_fma_f32 v37, v37, s51, v5
    v_exp_f32_dpp v26, v24 quad_perm:[0,0,0,0] row_mask:0xf bank_mask:0xf
    v_exp_f32_dpp v27, v25 quad_perm:[0,0,0,0] row_mask:0xf bank_mask:0xf
    v_exp_f32_dpp v30, v28 quad_perm:[0,0,0,0] row_mask:0xf bank_mask:0xf
    v_exp_f32_dpp v31, v29 quad_perm:[0,0,0,0] row_mask:0xf bank_mask:0xf
    v_exp_f32_dpp v34, v32 quad_perm:[0,0,0,0] row_mask:0xf bank_mask:0xf
    v_exp_f32_dpp v35, v33 quad_perm:[0,0,0,0] row_mask:0xf bank_mask:0xf
    v_exp_f32_dpp v38, v36 quad_perm:[0,0,0,0] row_mask:0xf bank_mask:0xf
    v_exp_f32_dpp v39, v37 quad_perm:[0,0,0,0] row_mask:0xf bank_mask:0xf
    v_add_f32 v4, v4, v26
    v_cvt_pk_bf16_f32 v64, v26, v27
    v_add_f32 v4, v4, v27
    v_add_f32 v4, v4, v30
    v_cvt_pk_bf16_f32 v65, v30, v31
    v_add_f32 v4, v4, v31
    v_add_f32 v4, v4, v34
    v_cvt_pk_bf16_f32 v66, v34, v35
    v_add_f32 v4, v4, v35
    v_add_f32 v4, v4, v38
    v_cvt_pk_bf16_f32 v67, v38, v39
    v_add_f32 v4, v4, v39
    s_waitcnt vmcnt(9)
    buffer_load_dwordx4 v[232:235], v2, s[44:47], s49 offen offset:2048 nt
    v_lshlrev_b32 v24, 16, v68
    v_and_b32 v25, s39, v68
    v_fma_f32 v24, v24, s51, v5
    v_fma_f32 v25, v25, s51, v5
    v_lshlrev_b32 v28, 16, v69
    v_and_b32 v29, s39, v69
    v_fma_f32 v28, v28, s51, v5
    v_fma_f32 v29, v29, s51, v5
    v_lshlrev_b32 v32, 16, v70
    v_and_b32 v33, s39, v70
    v_fma_f32 v32, v32, s51, v5
    v_fma_f32 v33, v33, s51, v5
    v_lshlrev_b32 v36, 16, v71
    v_and_b32 v37, s39, v71
    v_fma_f32 v36, v36, s51, v5
    v_fma_f32 v37, v37, s51, v5
    v_exp_f32_dpp v26, v24 quad_perm:[0,0,0,0] row_mask:0xf bank_mask:0xf
    v_exp_f32_dpp v27, v25 quad_perm:[0,0,0,0] row_mask:0xf bank_mask:0xf
    v_exp_f32_dpp v30, v28 quad_perm:[0,0,0,0] row_mask:0xf bank_mask:0xf
    v_exp_f32_dpp v31, v29 quad_perm:[0,0,0,0] row_mask:0xf bank_mask:0xf
    v_exp_f32_dpp v34, v32 quad_perm:[0,0,0,0] row_mask:0xf bank_mask:0xf
    v_exp_f32_dpp v35, v33 quad_perm:[0,0,0,0] row_mask:0xf bank_mask:0xf
    v_exp_f32_dpp v38, v36 quad_perm:[0,0,0,0] row_mask:0xf bank_mask:0xf
    v_exp_f32_dpp v39, v37 quad_perm:[0,0,0,0] row_mask:0xf bank_mask:0xf
    v_add_f32 v4, v4, v26
    v_cvt_pk_bf16_f32 v68, v26, v27
    v_add_f32 v4, v4, v27
    v_add_f32 v4, v4, v30
    v_cvt_pk_bf16_f32 v69, v30, v31
    v_add_f32 v4, v4, v31
    v_add_f32 v4, v4, v34
    v_cvt_pk_bf16_f32 v70, v34, v35
    v_add_f32 v4, v4, v35
    v_add_f32 v4, v4, v38
    v_cvt_pk_bf16_f32 v71, v38, v39
    v_add_f32 v4, v4, v39
    s_waitcnt vmcnt(9)
    buffer_load_dwordx4 v[236:239], v2, s[44:47], s49 offen offset:3072 nt
    v_mov_b32 v6, v4
    s_nop 1
    v_permlane16_swap_b32 v4, v6
    v_add_f32 v4, v4, v6
    v_mov_b32 v6, v4
    s_nop 1
    v_permlane32_swap_b32 v4, v6
    v_add_f32 v4, v4, v6
    v_bfe_u32 v6, v0, 3, 1
    s_lshl_b32 s3, s30, 4
    v_lshl_add_u32 v6, v6, 3, s3
    s_mov_b64 exec, 0x101
    v_mov_b32 v24, v3
    v_mov_b32 v25, v4
    ds_write_b64 v6, v[24:25] offset:512
    s_mov_b64 exec, -1
    v_perm_b32 v28, v40, v40, v12
    v_perm_b32 v29, v40, v40, v13
    v_perm_b32 v30, v40, v40, v14
    v_perm_b32 v31, v40, v40, v15
    s_nop 1
    v_mfma_f32_16x16x32_bf16 v[20:23], v[28:31], v[248:251], 0
    v_perm_b32 v32, v40, v40, v16
    v_perm_b32 v33, v40, v40, v17
    v_perm_b32 v34, v40, v40, v18
    v_perm_b32 v35, v40, v40, v19
    s_nop 1
    v_mfma_f32_16x16x32_bf16 v[20:23], v[32:35], v[252:255], v[20:23]
    v_perm_b32 v36, v41, v41, v12
    v_perm_b32 v37, v41, v41, v13
    v_perm_b32 v38, v41, v41, v14
    v_perm_b32 v39, v41, v41, v15
    s_nop 1
    v_mfma_f32_16x16x32_bf16 v[20:23], v[36:39], v[72:75], v[20:23]
    s_waitcnt vmcnt(4)
    s_add_u32 s54, s54, 0x4000
    s_and_b32 s54, s54, 0x3ffff
    s_add_u32 s49, s48, s54
    buffer_load_dwordx4 v[240:243], v2, s[44:47], s49 offen offset:0 nt
    v_perm_b32 v24, v41, v41, v16
    v_perm_b32 v25, v41, v41, v17
    v_perm_b32 v26, v41, v41, v18
    v_perm_b32 v27, v41, v41, v19
    s_nop 1
    v_mfma_f32_16x16x32_bf16 v[20:23], v[24:27], v[76:79], v[20:23]
    v_perm_b32 v28, v42, v42, v12
    v_perm_b32 v29, v42, v42, v13
    v_perm_b32 v30, v42, v42, v14
    v_perm_b32 v31, v42, v42, v15
    s_nop 1
    v_mfma_f32_16x16x32_bf16 v[20:23], v[28:31], v[80:83], v[20:23]
    v_perm_b32 v32, v42, v42, v16
    v_perm_b32 v33, v42, v42, v17
    v_perm_b32 v34, v42, v42, v18
    v_perm_b32 v35, v42, v42, v19
    s_nop 1
    v_mfma_f32_16x16x32_bf16 v[20:23], v[32:35], v[84:87], v[20:23]
    s_waitcnt vmcnt(4)
    buffer_load_dwordx4 v[244:247], v2, s[44:47], s49 offen offset:1024 nt
    v_perm_b32 v36, v43, v43, v12
    v_perm_b32 v37, v43, v43, v13
    v_perm_b32 v38, v43, v43, v14
    v_perm_b32 v39, v43, v43, v15
    s_nop 1
    v_mfma_f32_16x16x32_bf16 v[20:23], v[36:39], v[88:91], v[20:23]
    v_perm_b32 v24, v43, v43, v16
    v_perm_b32 v25, v43, v43, v17
    v_perm_b32 v26, v43, v43, v18
    v_perm_b32 v27, v43, v43, v19
    s_nop 1
    v_mfma_f32_16x16x32_bf16 v[20:23], v[24:27], v[92:95], v[20:23]
    v_perm_b32 v28, v44, v44, v12
    v_perm_b32 v29, v44, v44, v13
    v_perm_b32 v30, v44, v44, v14
    v_perm_b32 v31, v44, v44, v15
    s_nop 1
    v_mfma_f32_16x16x32_bf16 v[20:23], v[28:31], v[96:99], v[20:23]
    s_waitcnt vmcnt(4)
    buffer_load_dwordx4 v[100:103], v2, s[44:47], s49 offen offset:2048 nt
    v_perm_b32 v32, v44, v44, v16
    v_perm_b32 v33, v44, v44, v17
    v_perm_b32 v34, v44, v44, v18
    v_perm_b32 v35, v44, v44, v19
    s_nop 1
    v_mfma_f32_16x16x32_bf16 v[20:23], v[32:35], v[116:119], v[20:23]
    v_perm_b32 v36, v45, v45, v12
    v_perm_b32 v37, v45, v45, v13
    v_perm_b32 v38, v45, v45, v14
    v_perm_b32 v39, v45, v45, v15
    s_nop 1
    v_mfma_f32_16x16x32_bf16 v[20:23], v[36:39], v[120:123], v[20:23]
    v_perm_b32 v24, v45, v45, v16
    v_perm_b32 v25, v45, v45, v17
    v_perm_b32 v26, v45, v45, v18
    v_perm_b32 v27, v45, v45, v19
    s_nop 1
    v_mfma_f32_16x16x32_bf16 v[20:23], v[24:27], v[140:143], v[20:23]
    s_waitcnt vmcnt(4)
    buffer_load_dwordx4 v[104:107], v2, s[44:47], s49 offen offset:3072 nt
    v_perm_b32 v28, v46, v46, v12
    v_perm_b32 v29, v46, v46, v13
    v_perm_b32 v30, v46, v46, v14
    v_perm_b32 v31, v46, v46, v15
    s_nop 1
    v_mfma_f32_16x16x32_bf16 v[20:23], v[28:31], v[160:163], v[20:23]
    v_perm_b32 v32, v46, v46, v16
    v_perm_b32 v33, v46, v46, v17
    v_perm_b32 v34, v46, v46, v18
    v_perm_b32 v35, v46, v46, v19
    s_nop 1
    v_mfma_f32_16x16x32_bf16 v[20:23], v[32:35], v[180:183], v[20:23]
    v_perm_b32 v36, v47, v47, v12
    v_perm_b32 v37, v47, v47, v13
    v_perm_b32 v38, v47, v47, v14
    v_perm_b32 v39, v47, v47, v15
    s_nop 1
    v_mfma_f32_16x16x32_bf16 v[20:23], v[36:39], v[200:203], v[20:23]
    s_waitcnt vmcnt(4)
    s_add_u32 s54, s54, 0x4000
    s_and_b32 s54, s54, 0x3ffff
    s_add_u32 s49, s48, s54
    buffer_load_dwordx4 v[108:111], v2, s[44:47], s49 offen offset:0 nt
    v_perm_b32 v24, v47, v47, v16
    v_perm_b32 v25, v47, v47, v17
    v_perm_b32 v26, v47, v47, v18
    v_perm_b32 v27, v47, v47, v19
    s_nop 1
    v_mfma_f32_16x16x32_bf16 v[20:23], v[24:27], v[204:207], v[20:23]
    v_perm_b32 v28, v48, v48, v12
    v_perm_b32 v29, v48, v48, v13
    v_perm_b32 v30, v48, v48, v14
    v_perm_b32 v31, v48, v48, v15
    s_nop 1
    v_mfma_f32_16x16x32_bf16 v[20:23], v[28:31], v[208:211], v[20:23]
    v_perm_b32 v32, v48, v48, v16
    v_perm_b32 v33, v48, v48, v17
    v_perm_b32 v34, v48, v48, v18
    v_perm_b32 v35, v48, v48, v19
    s_nop 1
    v_mfma_f32_16x16x32_bf16 v[20:23], v[32:35], v[212:215], v[20:23]
    s_waitcnt vmcnt(4)
    buffer_load_dwordx4 v[112:115], v2, s[44:47], s49 offen offset:1024 nt
    v_perm_b32 v36, v49, v49, v12
    v_perm_b32 v37, v49, v49, v13
    v_perm_b32 v38, v49, v49, v14
    v_perm_b32 v39, v49, v49, v15
    s_nop 1
    v_mfma_f32_16x16x32_bf16 v[20:23], v[36:39], v[216:219], v[20:23]
    v_perm_b32 v24, v49, v49, v16
    v_perm_b32 v25, v49, v49, v17
    v_perm_b32 v26, v49, v49, v18
    v_perm_b32 v27, v49, v49, v19
    s_nop 1
    v_mfma_f32_16x16x32_bf16 v[20:23], v[24:27], v[220:223], v[20:23]
    v_perm_b32 v28, v50, v50, v12
    v_perm_b32 v29, v50, v50, v13
    v_perm_b32 v30, v50, v50, v14
    v_perm_b32 v31, v50, v50, v15
    s_nop 1
    v_mfma_f32_16x16x32_bf16 v[20:23], v[28:31], v[224:227], v[20:23]
    s_waitcnt vmcnt(4)
    buffer_load_dwordx4 v[124:127], v2, s[44:47], s49 offen offset:2048 nt
    v_perm_b32 v32, v50, v50, v16
    v_perm_b32 v33, v50, v50, v17
    v_perm_b32 v34, v50, v50, v18
    v_perm_b32 v35, v50, v50, v19
    s_nop 1
    v_mfma_f32_16x16x32_bf16 v[20:23], v[32:35], v[228:231], v[20:23]
    v_perm_b32 v36, v51, v51, v12
    v_perm_b32 v37, v51, v51, v13
    v_perm_b32 v38, v51, v51, v14
    v_perm_b32 v39, v51, v51, v15
    s_nop 1
    v_mfma_f32_16x16x32_bf16 v[20:23], v[36:39], v[232:235], v[20:23]
    v_perm_b32 v24, v51, v51, v16
    v_perm_b32 v25, v51, v51, v17
    v_perm_b32 v26, v51, v51, v18
    v_perm_b32 v27, v51, v51, v19
    s_nop 1
    v_mfma_f32_16x16x32_bf16 v[20:23], v[24:27], v[236:239], v[20:23]
    s_waitcnt vmcnt(4)
    buffer_load_dwordx4 v[128:131], v2, s[44:47], s49 offen offset:3072 nt
    v_perm_b32 v28, v52, v52, v12
    v_perm_b32 v29, v52, v52, v13
    v_perm_b32 v30, v52, v52, v14
    v_perm_b32 v31, v52, v52, v15
    s_nop 1
    v_mfma_f32_16x16x32_bf16 v[20:23], v[28:31], v[240:243], v[20:23]
    v_perm_b32 v32, v52, v52, v16
    v_perm_b32 v33, v52, v52, v17
    v_perm_b32 v34, v52, v52, v18
    v_perm_b32 v35, v52, v52, v19
    s_nop 1
    v_mfma_f32_16x16x32_bf16 v[20:23], v[32:35], v[244:247], v[20:23]
    v_perm_b32 v36, v53, v53, v12
    v_perm_b32 v37, v53, v53, v13
    v_perm_b32 v38, v53, v53, v14
    v_perm_b32 v39, v53, v53, v15
    s_nop 1
    v_mfma_f32_16x16x32_bf16 v[20:23], v[36:39], v[100:103], v[20:23]
    s_waitcnt vmcnt(4)
    s_add_u32 s54, s54, 0x4000
    s_and_b32 s54, s54, 0x3ffff
    s_add_u32 s49, s48, s54
    buffer_load_dwordx4 v[132:135], v2, s[44:47], s49 offen offset:0 nt
    v_perm_b32 v24, v53, v53, v16
    v_perm_b32 v25, v53, v53, v17
    v_perm_b32 v26, v53, v53, v18
    v_perm_b32 v27, v53, v53, v19
    s_nop 1
    v_mfma_f32_16x16x32_bf16 v[20:23], v[24:27], v[104:107], v[20:23]
    s_waitcnt vmcnt(4)
    buffer_load_dwordx4 v[136:139], v2, s[44:47], s49 offen offset:1024 nt
    v_perm_b32 v28, v54, v54, v12
    v_perm_b32 v29, v54, v54, v13
    v_perm_b32 v30, v54, v54, v14
    v_perm_b32 v31, v54, v54, v15
    s_nop 1
    v_mfma_f32_16x16x32_bf16 v[20:23], v[28:31], v[108:111], v[20:23]
    s_waitcnt vmcnt(4)
    buffer_load_dwordx4 v[144:147], v2, s[44:47], s49 offen offset:2048 nt
    v_perm_b32 v32, v54, v54, v16
    v_perm_b32 v33, v54, v54, v17
    v_perm_b32 v34, v54, v54, v18
    v_perm_b32 v35, v54, v54, v19
    s_nop 1
    v_mfma_f32_16x16x32_bf16 v[20:23], v[32:35], v[112:115], v[20:23]
    s_waitcnt vmcnt(4)
    buffer_load_dwordx4 v[148:151], v2, s[44:47], s49 offen offset:3072 nt
    v_perm_b32 v36, v55, v55, v12
    v_perm_b32 v37, v55, v55, v13
    v_perm_b32 v38, v55, v55, v14
    v_perm_b32 v39, v55, v55, v15
    s_nop 1
    v_mfma_f32_16x16x32_bf16 v[20:23], v[36:39], v[124:127], v[20:23]
    s_waitcnt vmcnt(4)
    s_add_u32 s54, s54, 0x4000
    s_and_b32 s54, s54, 0x3ffff
    s_add_u32 s49, s48, s54
    buffer_load_dwordx4 v[152:155], v2, s[44:47], s49 offen offset:0 nt
    v_perm_b32 v24, v55, v55, v16
    v_perm_b32 v25, v55, v55, v17
    v_perm_b32 v26, v55, v55, v18
    v_perm_b32 v27, v55, v55, v19
    s_nop 1
    v_mfma_f32_16x16x32_bf16 v[20:23], v[24:27], v[128:131], v[20:23]
    s_waitcnt vmcnt(4)
    buffer_load_dwordx4 v[156:159], v2, s[44:47], s49 offen offset:1024 nt
    v_perm_b32 v28, v56, v56, v12
    v_perm_b32 v29, v56, v56, v13
    v_perm_b32 v30, v56, v56, v14
    v_perm_b32 v31, v56, v56, v15
    s_nop 1
    v_mfma_f32_16x16x32_bf16 v[20:23], v[28:31], v[132:135], v[20:23]
    s_waitcnt vmcnt(4)
    buffer_load_dwordx4 v[164:167], v2, s[44:47], s49 offen offset:2048 nt
    v_perm_b32 v32, v56, v56, v16
    v_perm_b32 v33, v56, v56, v17
    v_perm_b32 v34, v56, v56, v18
    v_perm_b32 v35, v56, v56, v19
    s_nop 1
    v_mfma_f32_16x16x32_bf16 v[20:23], v[32:35], v[136:139], v[20:23]
    s_waitcnt vmcnt(4)
    buffer_load_dwordx4 v[168:171], v2, s[44:47], s49 offen offset:3072 nt
    v_perm_b32 v36, v57, v57, v12
    v_perm_b32 v37, v57, v57, v13
    v_perm_b32 v38, v57, v57, v14
    v_perm_b32 v39, v57, v57, v15
    s_nop 1
    v_mfma_f32_16x16x32_bf16 v[20:23], v[36:39], v[144:147], v[20:23]
    s_waitcnt vmcnt(4)
    s_add_u32 s54, s54, 0x4000
    s_and_b32 s54, s54, 0x3ffff
    s_add_u32 s49, s48, s54
    buffer_load_dwordx4 v[172:175], v2, s[44:47], s49 offen offset:0 nt
    v_perm_b32 v24, v57, v57, v16
    v_perm_b32 v25, v57, v57, v17
    v_perm_b32 v26, v57, v57, v18
    v_perm_b32 v27, v57, v57, v19
    s_nop 1
    v_mfma_f32_16x16x32_bf16 v[20:23], v[24:27], v[148:151], v[20:23]
    s_waitcnt vmcnt(4)
    buffer_load_dwordx4 v[176:179], v2, s[44:47], s49 offen offset:1024 nt
    v_perm_b32 v28, v58, v58, v12
    v_perm_b32 v29, v58, v58, v13
    v_perm_b32 v30, v58, v58, v14
    v_perm_b32 v31, v58, v58, v15
    s_nop 1
    v_mfma_f32_16x16x32_bf16 v[20:23], v[28:31], v[152:155], v[20:23]
    s_waitcnt vmcnt(4)
    buffer_load_dwordx4 v[184:187], v2, s[44:47], s49 offen offset:2048 nt
    v_perm_b32 v32, v58, v58, v16
    v_perm_b32 v33, v58, v58, v17
    v_perm_b32 v34, v58, v58, v18
    v_perm_b32 v35, v58, v58, v19
    s_nop 1
    v_mfma_f32_16x16x32_bf16 v[20:23], v[32:35], v[156:159], v[20:23]
    s_waitcnt vmcnt(4)
    buffer_load_dwordx4 v[188:191], v2, s[44:47], s49 offen offset:3072 nt
    v_perm_b32 v36, v59, v59, v12
    v_perm_b32 v37, v59, v59, v13
    v_perm_b32 v38, v59, v59, v14
    v_perm_b32 v39, v59, v59, v15
    s_nop 1
    v_mfma_f32_16x16x32_bf16 v[20:23], v[36:39], v[164:167], v[20:23]
    s_waitcnt vmcnt(4)
    s_add_u32 s54, s54, 0x4000
    s_and_b32 s54, s54, 0x3ffff
    s_add_u32 s49, s48, s54
    buffer_load_dwordx4 v[192:195], v2, s[44:47], s49 offen offset:0 nt
    v_mov_b32 v6, 2
    v_mov_b32 v8, 0
    s_mov_b64 exec, 1
    ds_max_i32 v8, v6 offset:772
    s_mov_b64 exec, -1
    v_perm_b32 v24, v59, v59, v16
    v_perm_b32 v25, v59, v59, v17
    v_perm_b32 v26, v59, v59, v18
    v_perm_b32 v27, v59, v59, v19
    s_nop 1
    v_mfma_f32_16x16x32_bf16 v[20:23], v[24:27], v[168:171], v[20:23]
    s_waitcnt vmcnt(4)
    buffer_load_dwordx4 v[196:199], v2, s[44:47], s49 offen offset:1024 nt
    v_perm_b32 v28, v60, v60, v12
    v_perm_b32 v29, v60, v60, v13
    v_perm_b32 v30, v60, v60, v14
    v_perm_b32 v31, v60, v60, v15
    s_nop 1
    v_mfma_f32_16x16x32_bf16 v[20:23], v[28:31], v[172:175], v[20:23]
    s_waitcnt vmcnt(4)
    buffer_load_dwordx4 v[248:251], v2, s[44:47], s49 offen offset:2048 nt
    v_perm_b32 v32, v60, v60, v16
    v_perm_b32 v33, v60, v60, v17
    v_perm_b32 v34, v60, v60, v18
    v_perm_b32 v35, v60, v60, v19
    s_nop 1
    v_mfma_f32_16x16x32_bf16 v[20:23], v[32:35], v[176:179], v[20:23]
    s_waitcnt vmcnt(4)
    buffer_load_dwordx4 v[252:255], v2, s[44:47], s49 offen offset:3072 nt
    v_perm_b32 v36, v61, v61, v12
    v_perm_b32 v37, v61, v61, v13
    v_perm_b32 v38, v61, v61, v14
    v_perm_b32 v39, v61, v61, v15
    s_nop 1
    v_mfma_f32_16x16x32_bf16 v[20:23], v[36:39], v[184:187], v[20:23]
    s_waitcnt vmcnt(4)
    s_add_u32 s54, s54, 0x4000
    s_and_b32 s54, s54, 0x3ffff
    s_add_u32 s49, s48, s54
    buffer_load_dwordx4 v[72:75], v2, s[44:47], s49 offen offset:0 nt
    v_perm_b32 v24, v61, v61, v16
    v_perm_b32 v25, v61, v61, v17
    v_perm_b32 v26, v61, v61, v18
    v_perm_b32 v27, v61, v61, v19
    s_nop 1
    v_mfma_f32_16x16x32_bf16 v[20:23], v[24:27], v[188:191], v[20:23]
    s_waitcnt vmcnt(4)
    buffer_load_dwordx4 v[76:79], v2, s[44:47], s49 offen offset:1024 nt
    v_perm_b32 v28, v62, v62, v12
    v_perm_b32 v29, v62, v62, v13
    v_perm_b32 v30, v62, v62, v14
    v_perm_b32 v31, v62, v62, v15
    s_nop 1
    v_mfma_f32_16x16x32_bf16 v[20:23], v[28:31], v[192:195], v[20:23]
    s_waitcnt vmcnt(4)
    buffer_load_dwordx4 v[80:83], v2, s[44:47], s49 offen offset:2048 nt
    v_perm_b32 v32, v62, v62, v16
    v_perm_b32 v33, v62, v62, v17
    v_perm_b32 v34, v62, v62, v18
    v_perm_b32 v35, v62, v62, v19
    s_nop 1
    v_mfma_f32_16x16x32_bf16 v[20:23], v[32:35], v[196:199], v[20:23]
    s_waitcnt vmcnt(4)
    buffer_load_dwordx4 v[84:87], v2, s[44:47], s49 offen offset:3072 nt
    v_perm_b32 v36, v63, v63, v12
    v_perm_b32 v37, v63, v63, v13
    v_perm_b32 v38, v63, v63, v14
    v_perm_b32 v39, v63, v63, v15
    s_nop 1
    v_mfma_f32_16x16x32_bf16 v[20:23], v[36:39], v[248:251], v[20:23]
    s_waitcnt vmcnt(4)
    s_add_u32 s54, s54, 0x4000
    s_and_b32 s54, s54, 0x3ffff
    s_add_u32 s49, s48, s54
    buffer_load_dwordx4 v[88:91], v2, s[44:47], s49 offen offset:0 nt
    v_perm_b32 v24, v63, v63, v16
    v_perm_b32 v25, v63, v63, v17
    v_perm_b32 v26, v63, v63, v18
    v_perm_b32 v27, v63, v63, v19
    s_nop 1
    v_mfma_f32_16x16x32_bf16 v[20:23], v[24:27], v[252:255], v[20:23]
    s_waitcnt vmcnt(4)
    buffer_load_dwordx4 v[92:95], v2, s[44:47], s49 offen offset:1024 nt
    v_perm_b32 v28, v64, v64, v12
    v_perm_b32 v29, v64, v64, v13
    v_perm_b32 v30, v64, v64, v14
    v_perm_b32 v31, v64, v64, v15
    s_nop 1
    v_mfma_f32_16x16x32_bf16 v[20:23], v[28:31], v[72:75], v[20:23]
    s_waitcnt vmcnt(4)
    buffer_load_dwordx4 v[96:99], v2, s[44:47], s49 offen offset:2048 nt
    v_perm_b32 v32, v64, v64, v16
    v_perm_b32 v33, v64, v64, v17
    v_perm_b32 v34, v64, v64, v18
    v_perm_b32 v35, v64, v64, v19
    s_nop 1
    v_mfma_f32_16x16x32_bf16 v[20:23], v[32:35], v[76:79], v[20:23]
    s_waitcnt vmcnt(4)
    buffer_load_dwordx4 v[116:119], v2, s[44:47], s49 offen offset:3072 nt
    v_perm_b32 v36, v65, v65, v12
    v_perm_b32 v37, v65, v65, v13
    v_perm_b32 v38, v65, v65, v14
    v_perm_b32 v39, v65, v65, v15
    s_nop 1
    v_mfma_f32_16x16x32_bf16 v[20:23], v[36:39], v[80:83], v[20:23]
    s_waitcnt vmcnt(4)
    s_add_u32 s54, s54, 0x4000
    s_and_b32 s54, s54, 0x3ffff
    s_add_u32 s49, s48, s54
    buffer_load_dwordx4 v[120:123], v2, s[44:47], s49 offen offset:0 nt
    v_perm_b32 v24, v65, v65, v16
    v_perm_b32 v25, v65, v65, v17
    v_perm_b32 v26, v65, v65, v18
    v_perm_b32 v27, v65, v65, v19
    s_nop 1
    v_mfma_f32_16x16x32_bf16 v[20:23], v[24:27], v[84:87], v[20:23]
    s_waitcnt vmcnt(4)
    buffer_load_dwordx4 v[140:143], v2, s[44:47], s49 offen offset:1024 nt
    v_perm_b32 v28, v66, v66, v12
    v_perm_b32 v29, v66, v66, v13
    v_perm_b32 v30, v66, v66, v14
    v_perm_b32 v31, v66, v66, v15
    s_nop 1
    v_mfma_f32_16x16x32_bf16 v[20:23], v[28:31], v[88:91], v[20:23]
    s_waitcnt vmcnt(4)
    buffer_load_dwordx4 v[160:163], v2, s[44:47], s49 offen offset:2048 nt
    v_perm_b32 v32, v66, v66, v16
    v_perm_b32 v33, v66, v66, v17
    v_perm_b32 v34, v66, v66, v18
    v_perm_b32 v35, v66, v66, v19
    s_nop 1
    v_mfma_f32_16x16x32_bf16 v[20:23], v[32:35], v[92:95], v[20:23]
    s_waitcnt vmcnt(4)
    buffer_load_dwordx4 v[180:183], v2, s[44:47], s49 offen offset:3072 nt
    v_perm_b32 v36, v67, v67, v12
    v_perm_b32 v37, v67, v67, v13
    v_perm_b32 v38, v67, v67, v14
    v_perm_b32 v39, v67, v67, v15
    s_nop 1
    v_mfma_f32_16x16x32_bf16 v[20:23], v[36:39], v[96:99], v[20:23]
    s_waitcnt vmcnt(4)
    s_add_u32 s54, s54, 0x4000
    s_and_b32 s54, s54, 0x3ffff
    s_add_u32 s49, s48, s54
    buffer_load_dwordx4 v[200:203], v2, s[44:47], s49 offen offset:0 nt
    v_perm_b32 v24, v67, v67, v16
    v_perm_b32 v25, v67, v67, v17
    v_perm_b32 v26, v67, v67, v18
    v_perm_b32 v27, v67, v67, v19
    s_nop 1
    v_mfma_f32_16x16x32_bf16 v[20:23], v[24:27], v[116:119], v[20:23]
    s_waitcnt vmcnt(4)
    buffer_load_dwordx4 v[204:207], v2, s[44:47], s49 offen offset:1024 nt
    v_perm_b32 v28, v68, v68, v12
    v_perm_b32 v29, v68, v68, v13
    v_perm_b32 v30, v68, v68, v14
    v_perm_b32 v31, v68, v68, v15
    s_nop 1
    v_mfma_f32_16x16x32_bf16 v[20:23], v[28:31], v[120:123], v[20:23]
    s_waitcnt vmcnt(4)
    buffer_load_dwordx4 v[208:211], v2, s[44:47], s49 offen offset:2048 nt
    v_perm_b32 v32, v68, v68, v16
    v_perm_b32 v33, v68, v68, v17
    v_perm_b32 v34, v68, v68, v18
    v_perm_b32 v35, v68, v68, v19
    s_nop 1
    v_mfma_f32_16x16x32_bf16 v[20:23], v[32:35], v[140:143], v[20:23]
    s_waitcnt vmcnt(4)
    buffer_load_dwordx4 v[212:215], v2, s[44:47], s49 offen offset:3072 nt
    v_mov_b32 v6, 3
    v_mov_b32 v8, 0
    s_mov_b64 exec, 1
    v_mov_b32 v6, 1
    ds_add_u32 v8, v6 offset:776
    s_mov_b64 exec, -1
    s_lshl_b32 s3, s30, 10
    v_add_u32 v6, s3, v2
    v_perm_b32 v36, v69, v69, v12
    v_perm_b32 v37, v69, v69, v13
    v_perm_b32 v38, v69, v69, v14
    v_perm_b32 v39, v69, v69, v15
    s_nop 1
    v_mfma_f32_16x16x32_bf16 v[20:23], v[36:39], v[160:163], v[20:23]
    v_perm_b32 v24, v69, v69, v16
    v_perm_b32 v25, v69, v69, v17
    v_perm_b32 v26, v69, v69, v18
    v_perm_b32 v27, v69, v69, v19
    s_waitcnt vmcnt(4)
    s_nop 0
    v_mfma_f32_16x16x32_bf16 v[20:23], v[24:27], v[180:183], v[20:23]
    v_perm_b32 v28, v70, v70, v12
    v_perm_b32 v29, v70, v70, v13
    v_perm_b32 v30, v70, v70, v14
    v_perm_b32 v31, v70, v70, v15
    s_waitcnt vmcnt(3)
    s_nop 0
    v_mfma_f32_16x16x32_bf16 v[20:23], v[28:31], v[200:203], v[20:23]
    v_perm_b32 v32, v70, v70, v16
    v_perm_b32 v33, v70, v70, v17
    v_perm_b32 v34, v70, v70, v18
    v_perm_b32 v35, v70, v70, v19
    s_waitcnt vmcnt(2)
    s_nop 0
    v_mfma_f32_16x16x32_bf16 v[20:23], v[32:35], v[204:207], v[20:23]
    v_perm_b32 v36, v71, v71, v12
    v_perm_b32 v37, v71, v71, v13
    v_perm_b32 v38, v71, v71, v14
    v_perm_b32 v39, v71, v71, v15
    s_waitcnt vmcnt(1)
    s_nop 0
    v_mfma_f32_16x16x32_bf16 v[20:23], v[36:39], v[208:211], v[20:23]
    v_perm_b32 v24, v71, v71, v16
    v_perm_b32 v25, v71, v71, v17
    v_perm_b32 v26, v71, v71, v18
    v_perm_b32 v27, v71, v71, v19
    s_waitcnt vmcnt(0)
    s_nop 0
    v_mfma_f32_16x16x32_bf16 v[20:23], v[24:27], v[212:215], v[20:23]
    s_nop 7
    ds_write_b128 v6, v[20:23] offset:1024
    s_waitcnt lgkmcnt(0)
    s_barrier
    s_endpgm
.section .rodata,"a"
.p2align 6
.amdhsa_kernel recurrent_scan__gqa_block_cached__mixer_token_mlp__decode_kernel
  .amdhsa_next_free_vgpr 256
  .amdhsa_next_free_sgpr 96
  .amdhsa_accum_offset 256
  .amdhsa_group_segment_fixed_size 0
  .amdhsa_kernarg_size 104
  .amdhsa_user_sgpr_count 2
  .amdhsa_user_sgpr_kernarg_segment_ptr 1
  .amdhsa_system_sgpr_workgroup_id_x 1
  .amdhsa_float_denorm_mode_32 3
.end_amdhsa_kernel
```
